```python
import torch

def _softmax(x, axis=-1):
    return torch.softmax(x, dim=axis)
def _gelu(x):
    return torch.nn.functional.gelu(x, approximate="tanh")
def _silu(x):
    return torch.nn.functional.silu(x)
def _sigmoid(x):
    return torch.sigmoid(x)
def _layernorm(x, axis=-1, eps=1e-5):
    m = x.mean(dim=axis, keepdim=True)
    v = x.var(dim=axis, keepdim=True, unbiased=False)
    return (x - m) / torch.sqrt(v + eps)
def _scatter_add(tgt, idx, src, axis=0):
    return tgt.clone().index_add_(axis, idx, src)
def _segment_sum(src, seg, n):
    out = torch.zeros((n,) + src.shape[1:], dtype=src.dtype)
    return out.index_add_(0, seg, src)
def _pad(x, pw):
    flat = tuple(v for pair in reversed(pw) for v in pair)
    return torch.nn.functional.pad(x, flat)

kernel_name = 'parallel_sum__sliding_block_cached__glu_gated_reglu__decode'

def setup_inputs():

    _w = (lambda a: (lambda t: t.to(torch.bfloat16) if t.is_floating_point() else t)(torch.as_tensor(a)))
    def _A_setup():
        B, Sq, D = 4, 1, 448
        Hq, Hkv, Sk, Dh = 16, 8, 16384, 256
        assert Hq % Hkv == 0, (Hq, Hkv)
        return {
            "x": _w((lambda *s: torch.randn(*s, dtype=torch.bfloat16) * 0.05)(B, Sq, D)),
            "k_cache": _w((lambda *s: torch.randn(*s, dtype=torch.bfloat16) * 1.6)(B, Hkv, Sk, Dh)),
            "v_cache": _w((lambda *s: torch.randn(*s, dtype=torch.bfloat16) * 0.8)(B, Hkv, Sk, Dh)),
            "wq": _w((lambda *s: torch.randn(*s, dtype=torch.bfloat16) * 1.6)(D, Hq * Dh) * (D ** -0.5)),
            "wo": _w((lambda *s: torch.randn(*s, dtype=torch.bfloat16) * 0.8)(Hq * Dh, D) * ((Hq * Dh) ** -0.5)),
        }
    _A_in = _A_setup()

    def _B_setup():
        B, S, D, F = 4, 1, 448, 1792
        return {
            "x": _w((lambda *s: torch.randn(*s, dtype=torch.bfloat16) * 0.05)(B, S, D)),
            "W_gate": _w((lambda *s: torch.randn(*s, dtype=torch.bfloat16) * 0.4)(D, F) * (2.0 / D) ** 0.5),
            "W_up": _w((lambda *s: torch.randn(*s, dtype=torch.bfloat16) * 0.4)(D, F) * (2.0 / D) ** 0.5),
            "W_down": _w((lambda *s: torch.randn(*s, dtype=torch.bfloat16) * 0.4)(F, D) * (1.0 / F) ** 0.5),
        }
    _B_in = _B_setup()

    return {
        "A_x": _A_in["x"],
        "A_k_cache": _A_in["k_cache"],
        "A_v_cache": _A_in["v_cache"],
        "A_wq": _A_in["wq"],
        "A_wo": _A_in["wo"],
        "B_x": _B_in["x"],
        "B_W_gate": _B_in["W_gate"],
        "B_W_up": _B_in["W_up"],
        "B_W_down": _B_in["W_down"],
    }

def reference(A_x, A_k_cache, A_v_cache, A_wq, A_wo, B_x, B_W_gate, B_W_up, B_W_down):
    def _A_ref(x, k_cache, v_cache, wq, wo):
        B, Sq, D = x.shape
        Hq, Dh = 16, 256
        Hkv, Sk = k_cache.shape[1], k_cache.shape[2]
        W = min(4096, max(256, Sk // 4))
        rep = Hq // Hkv
        q = (lambda x, *d: x.permute(*d))((x @ wq).reshape(B, Sq, Hq, Dh), 0, 2, 1, 3)
        k = (lambda x, n, axis: torch.repeat_interleave(x, n, dim=axis))(k_cache[:, :, Sk - W:, :], rep, axis=1)
        v = (lambda x, n, axis: torch.repeat_interleave(x, n, dim=axis))(v_cache[:, :, Sk - W:, :], rep, axis=1)
        scores = torch.einsum("bhqd,bhkd->bhqk", q, k) * (Dh ** -0.5)
        p = _softmax(scores, axis=-1)
        o = torch.einsum("bhqk,bhkd->bhqd", p, v)
        return (lambda x, *d: x.permute(*d))(o, 0, 2, 1, 3).reshape(B, Sq, Hq * Dh) @ wo

    def _B_ref(x, W_gate, W_up, W_down):
        gate = torch.einsum("bsd,df->bsf", x, W_gate)
        up = torch.einsum("bsd,df->bsf", x, W_up)
        gate = gate * (lambda x, dt: x.to(dt))(gate > 0, gate.dtype)
        h = gate * up
        return torch.einsum("bsf,fd->bsd", h, W_down)

    x = A_x
    xn = _layernorm(x, axis=-1)
    return x + _A_ref(xn, A_k_cache, A_v_cache, A_wq, A_wo) + _B_ref(xn, B_W_gate, B_W_up, B_W_down)
```

```asm
; @launch grid=(256,1,1) block=(576,1,1) lds=163840
.amdgcn_target "amdgcn-amd-amdhsa--gfx950"
.text
.globl parallel_sum__sliding_block_cached__glu_gated_reglu__decode_kernel
.p2align 8
.type parallel_sum__sliding_block_cached__glu_gated_reglu__decode_kernel,@function
parallel_sum__sliding_block_cached__glu_gated_reglu__decode_kernel:
  s_load_dwordx2 s[8:9], s[0:1], 8
  v_readfirstlane_b32 s3, v0
  s_cmpk_ge_u32 s2, 256
  s_cbranch_scc1 L_end
  v_and_b32 v0, 63, v0
  s_lshr_b32 s3, s3, 6
  s_and_b32 s4, s2, 7
  s_bfe_u32 s5, s2, 0x30003
  s_lshr_b32 s6, s2, 6
  s_lshl3_add_u32 s56, s6, s4
  s_cmp_eq_u32 s3, 8
  s_cbranch_scc1 L_helper
  v_lshrrev_b32 v1, 4, v0
  v_and_b32 v1, 2, v1
  v_xor_b32 v1, v1, v0
  v_lshlrev_b32 v4, 4, v1
  v_xor_b32 v5, 64, v4
  v_xor_b32 v6, 0x80, v4
  v_xor_b32 v7, 64, v6
  s_lshl3_add_u32 s66, s5, s3
  s_lshl_b32 s57, s56, 23
  s_add_u32 s57, s57, 6291456
  s_lshl_b32 s59, s3, 14
  s_lshl_b32 s58, s66, 13
  s_brev_b32 s62, s5
  s_lshr_b32 s62, s62, 10
  s_and_b32 s62, s62, 0x180000
  s_or_b32 s58, s58, s62
  s_lshl_b32 s62, s66, 11
  s_and_b32 s62, s62, 0x1000
  s_or_b32 s58, s58, s62
  s_mov_b32 s10, 0x200000
  s_mov_b32 s11, 0x20000
  s_mov_b32 m0, s59
  s_waitcnt lgkmcnt(0)
  s_add_u32 s8, s8, s57
  s_addc_u32 s9, s9, 0
  s_load_dwordx16 s[16:31], s[0:1], 0
  s_load_dwordx8 s[32:39], s[0:1], 64
  buffer_load_dwordx4 v4, s[8:11], s58 offen offset:0 nt lds
  buffer_load_dwordx4 v5, s[8:11], s58 offen offset:1024 nt lds
  buffer_load_dwordx4 v6, s[8:11], s58 offen offset:2048 nt lds
  buffer_load_dwordx4 v7, s[8:11], s58 offen offset:3072 nt lds
  v_bfe_u32 v2, v0, 4, 2
  v_lshlrev_b32 v2, 1, v2
  v_and_b32 v3, 7, v0
  v_xor_b32 v2, v2, v3
  v_lshlrev_b32 v30, 4, v2
  v_lshrrev_b32 v31, 3, v0
  s_movk_i32 s61, 3584
  s_bfe_u32 s65, s2, 0x30004
  s_lshl3_add_u32 s65, s4, s65
  s_bfe_u32 s67, s2, 0x20005
  s_lshl2_add_u32 s67, s4, s67
  s_and_b32 s63, s5, 3
  s_and_b32 s64, s5, 1
  s_lshl_b32 s64, s64, 1
  s_cmp_lt_u32 s4, 7
  s_cselect_b32 s46, 1605632, 0
  s_cselect_b32 s67, s67, 0
  s_cmp_lt_u32 s6, 2
  s_cselect_b32 s46, 3670016, s46
  s_cselect_b32 s61, 0x2000, s61
  s_cselect_b32 s65, s65, s67
  s_cselect_b32 s63, s64, s63
  s_cselect_b32 s67, 917504, 0
  s_cselect_b64 vcc, -1, 0
  s_mul_i32 s63, s63, 7
  s_add_u32 s63, s63, s3
  s_lshl_b32 s63, s63, 4
  s_mul_i32 s63, s63, s61
  s_lshl_b32 s65, s65, 7
  s_add_u32 s63, s63, s65
  s_add_u32 s67, s67, s63
  v_mad_u32_u24 v21, v31, s61, v30
  s_lshl_b32 s61, s61, 3
  s_lshl_b32 s62, s3, 11
  s_mov_b32 s47, s11
  s_max_u32 s7, s4, s5
  v_mov_b32 v28, 1
  s_cmp_eq_u32 s3, 7
  s_waitcnt lgkmcnt(0)
  s_cbranch_scc1 L_ldx
  s_cmp_lg_u64 vcc, 0
  s_cselect_b64 s[44:45], s[22:23], s[28:29]
  s_cselect_b64 s[48:49], s[22:23], s[30:31]
  s_add_u32 m0, s62, 131072
  s_mov_b64 s[50:51], s[46:47]
  buffer_load_dwordx4 v21, s[44:47], s63 offen nt lds
  s_add_u32 m0, s62, 145408
  s_add_u32 s63, s63, s61
  buffer_load_dwordx4 v21, s[48:51], s67 offen nt lds
  s_add_u32 m0, s62, 132096
  s_add_u32 s67, s67, s61
  buffer_load_dwordx4 v21, s[44:47], s63 offen nt lds
  s_add_u32 m0, s62, 146432
  s_nop 0
  buffer_load_dwordx4 v21, s[48:51], s67 offen nt lds
  s_branch L_ldk
L_ldx:
  v_lshlrev_b32 v21, 4, v0
  s_mov_b32 m0, 160000
  s_mov_b64 s[44:45], s[16:17]
  s_movk_i32 s46, 3584
  buffer_load_dwordx4 v21, s[44:47], 0 offen lds
  buffer_load_dwordx4 v21, s[44:47], 0 offen offset:1024 lds
  buffer_load_dwordx4 v21, s[44:47], 0 offen offset:2048 lds
  s_mov_b32 exec_hi, 0
  buffer_load_dwordx4 v21, s[44:47], 0 offen offset:3072 lds
  s_mov_b32 exec_hi, -1
L_ldk:
  s_branch L_stream
L_helper:
  s_load_dwordx16 s[16:31], s[0:1], 0
  s_load_dwordx8 s[32:39], s[0:1], 64
  s_setprio 3
  s_getreg_b32 s57, hwreg(HW_REG_XCC_ID, 0, 7)
  s_lshl_b32 s66, s4, 5
  s_lshr_b32 s61, s2, 3
  s_add_u32 s61, s61, s66
  s_add_u32 s57, s57, 1
  v_mov_b32 v9, s61
  v_mov_b32 v10, s57
  v_mov_b32 v31, 159744
  v_lshl_add_u32 v1, v0, 2, v31
  v_mov_b32 v2, 0
  ds_write_b32 v1, v2
  s_mov_b64 exec, 1
  s_waitcnt lgkmcnt(0)
  global_store_byte v9, v10, s[36:37]
  s_load_dword s62, s[38:39], 0
  s_mov_b64 exec, -1
  s_mov_b64 s[40:41], s[38:39]
  s_mov_b32 s42, 1966080
  s_mov_b32 s43, 0x20000
  s_mul_i32 s67, s56, 12288
  s_add_u32 s67, s67, 786432
  s_mul_i32 s64, s6, 7
  s_add_u32 s64, s64, s5
  s_lshl_b32 s7, s56, 9
  s_add_u32 s7, s7, 245760
  s_cmp_eq_u32 s5, 7
  s_cbranch_scc1 L_nors
  s_lshl3_add_u32 s60, s64, s4
  s_lshl_b32 s60, s60, 8
  s_add_u32 s60, s60, 1835008
  v_lshlrev_b32 v8, 2, v0
  v_mov_b32 v11, -1
  buffer_store_dword v11, v8, s[40:43], s60 offen sc1
L_nors:
  v_lshlrev_b32 v8, 7, v0
  s_cmp_lg_u32 s5, 7
  s_cbranch_scc1 L_nopre
  s_mov_b64 exec, 3
  buffer_load_dword v166, v8, s[40:43], s7 offen sc1
L_nopre:
  s_mov_b64 exec, -1
  v_lshrrev_b32 v1, 4, v0
  v_and_b32 v2, 15, v0
  v_and_b32 v3, 3, v0
  v_mul_u32_u24 v3, 896, v3
  v_add_u32 v3, 160000, v3
  v_lshl_add_u32 v4, v1, 3, v3
  v_and_b32 v5, 60, v0
  v_lshl_add_u32 v3, v5, 1, v3
  s_and_b32 s60, s5, 3
  s_and_b32 s61, s5, 1
  s_lshl_b32 s65, s61, 11
  s_bfe_u32 s59, s2, 0x30004
  s_lshl_b32 s59, s59, 8
  s_add_u32 s65, s65, s59
  s_lshl_b32 s63, s60, 11
  s_bfe_u32 s59, s2, 0x20005
  s_lshl_b32 s59, s59, 9
  s_add_u32 s63, s63, s59
  s_add_u32 s63, s63, 4096
  s_lshl_b32 s61, s61, 1
  s_cmp_lt_u32 s6, 2
  s_cselect_b32 s60, s61, s60
  s_cselect_b32 s61, 224, 0
  s_cselect_b32 s65, s65, s63
  s_mul_i32 s60, s60, 224
  v_add_u32 v4, s60, v4
  v_add_u32 v5, s61, v4
  s_mul_i32 s60, s4, 12288
  s_add_u32 s65, s65, s60
  s_add_u32 s65, s65, 786432
  v_lshrrev_b32 v7, 2, v0
  v_lshlrev_b32 v7, 7, v7
  v_bfe_u32 v6, v0, 3, 2
  v_lshl_add_u32 v7, v6, 5, v7
  v_and_b32 v6, 3, v0
  v_lshl_add_u32 v7, v6, 3, v7
  v_add_u32 v156, 131072, v7
  v_xor_b32 v157, 32, v156
  v_xor_b32 v158, 64, v156
  v_xor_b32 v159, 0x60, v156
  s_mov_b64 s[8:9], 0xffff
  s_lshl_b64 s[10:11], s[8:9], 16
  s_lshl_b64 s[12:13], s[8:9], 32
  v_mov_b32 v30, 1
  v_lshlrev_b32 v29, 3, v0
  v_lshlrev_b32 v7, 4, v0
  v_lshlrev_b32 v6, 2, v0
  s_min_u32 s60, s64, 27
  s_lshl_b32 s60, s60, 7
  v_lshl_add_u32 v162, v0, 1, s60
  v_add_u32 v163, 160000, v162
  v_and_b32 v160, 7, v0
  v_lshlrev_b32 v160, 2, v160
  v_add_u32 v160, s66, v160
  s_mul_i32 s46, s57, 0x01010101
  global_load_dword v161, v160, s[36:37] sc1
  s_barrier
  s_mov_b32 s63, 3200000
L_w0:
  ds_read_b32 v9, v31 offset:12
  s_sub_u32 s63, s63, 1
  s_waitcnt lgkmcnt(0)
  s_cbranch_scc1 L_w0_done
  v_cmp_le_u32 vcc, 8, v9
  s_cbranch_vccnz L_w0_done
  s_sleep 1
  s_branch L_w0
L_w0_done:
  ds_read_b64 v[8:9], v3 offset:0
  ds_read_b64 v[10:11], v3 offset:128
  ds_read_b64 v[12:13], v3 offset:256
  ds_read_b64 v[14:15], v3 offset:384
  ds_read_b64 v[16:17], v3 offset:512
  ds_read_b64 v[18:19], v3 offset:640
  ds_read_b64 v[20:21], v3 offset:768
  ds_read_u16 v163, v163
  ds_read_b64_tr_b16 v[64:65], v156 offset:0
  ds_read_b64_tr_b16 v[78:79], v157 offset:0
  ds_read_b64_tr_b16 v[92:93], v158 offset:0
  ds_read_b64_tr_b16 v[106:107], v159 offset:0
  ds_read_b64_tr_b16 v[66:67], v156 offset:2048
  ds_read_b64_tr_b16 v[80:81], v157 offset:2048
  ds_read_b64_tr_b16 v[94:95], v158 offset:2048
  ds_read_b64_tr_b16 v[108:109], v159 offset:2048
  ds_read_b64_tr_b16 v[68:69], v156 offset:4096
  ds_read_b64_tr_b16 v[82:83], v157 offset:4096
  ds_read_b64_tr_b16 v[96:97], v158 offset:4096
  ds_read_b64_tr_b16 v[110:111], v159 offset:4096
  ds_read_b64_tr_b16 v[70:71], v156 offset:6144
  ds_read_b64_tr_b16 v[84:85], v157 offset:6144
  ds_read_b64_tr_b16 v[98:99], v158 offset:6144
  ds_read_b64_tr_b16 v[112:113], v159 offset:6144
  ds_read_b64_tr_b16 v[72:73], v156 offset:8192
  ds_read_b64_tr_b16 v[86:87], v157 offset:8192
  ds_read_b64_tr_b16 v[100:101], v158 offset:8192
  ds_read_b64_tr_b16 v[114:115], v159 offset:8192
  ds_read_b64_tr_b16 v[74:75], v156 offset:10240
  ds_read_b64_tr_b16 v[88:89], v157 offset:10240
  ds_read_b64_tr_b16 v[102:103], v158 offset:10240
  ds_read_b64_tr_b16 v[116:117], v159 offset:10240
  ds_read_b64_tr_b16 v[76:77], v156 offset:12288
  ds_read_b64_tr_b16 v[90:91], v157 offset:12288
  ds_read_b64_tr_b16 v[104:105], v158 offset:12288
  ds_read_b64_tr_b16 v[118:119], v159 offset:12288
  s_mul_i32 s62, s62, 1664525
  s_add_u32 s62, s62, 1013904223
  v_mov_b32 v28, s62
  s_movk_i32 s47, 0xff
  s_waitcnt lgkmcnt(15)
  v_lshlrev_b32 v32, 16, v8
  v_and_b32 v33, 0xffff0000, v8
  v_lshlrev_b32 v34, 16, v9
  v_and_b32 v35, 0xffff0000, v9
  v_lshlrev_b32 v36, 16, v10
  v_and_b32 v37, 0xffff0000, v10
  v_lshlrev_b32 v38, 16, v11
  v_and_b32 v39, 0xffff0000, v11
  v_lshlrev_b32 v40, 16, v12
  v_and_b32 v41, 0xffff0000, v12
  v_lshlrev_b32 v42, 16, v13
  v_and_b32 v43, 0xffff0000, v13
  v_lshlrev_b32 v44, 16, v14
  v_and_b32 v45, 0xffff0000, v14
  v_lshlrev_b32 v46, 16, v15
  v_and_b32 v47, 0xffff0000, v15
  v_lshlrev_b32 v48, 16, v16
  v_and_b32 v49, 0xffff0000, v16
  v_lshlrev_b32 v50, 16, v17
  v_and_b32 v51, 0xffff0000, v17
  v_lshlrev_b32 v52, 16, v18
  v_and_b32 v53, 0xffff0000, v18
  v_lshlrev_b32 v54, 16, v19
  v_and_b32 v55, 0xffff0000, v19
  v_lshlrev_b32 v56, 16, v20
  v_and_b32 v57, 0xffff0000, v20
  v_lshlrev_b32 v58, 16, v21
  v_and_b32 v59, 0xffff0000, v21
  v_pk_add_f32 v[22:23], v[32:33], v[34:35]
  v_pk_add_f32 v[26:27], v[36:37], v[38:39]
  v_pk_add_f32 v[22:23], v[22:23], v[40:41]
  v_pk_add_f32 v[26:27], v[26:27], v[42:43]
  v_pk_add_f32 v[22:23], v[22:23], v[44:45]
  v_pk_add_f32 v[26:27], v[26:27], v[46:47]
  v_pk_add_f32 v[22:23], v[22:23], v[48:49]
  v_pk_add_f32 v[26:27], v[26:27], v[50:51]
  v_pk_add_f32 v[22:23], v[22:23], v[52:53]
  v_pk_add_f32 v[26:27], v[26:27], v[54:55]
  v_pk_add_f32 v[22:23], v[22:23], v[56:57]
  v_pk_add_f32 v[26:27], v[26:27], v[58:59]
  v_pk_add_f32 v[22:23], v[22:23], v[26:27]
  v_add_f32 v22, v22, v23
  s_nop 1
  v_add_f32_dpp v22, v22, v22 row_ror:4 row_mask:0xf bank_mask:0xf
  s_nop 1
  v_add_f32_dpp v22, v22, v22 row_ror:8 row_mask:0xf bank_mask:0xf
  v_mov_b32 v23, v22
  s_nop 1
  v_permlane16_swap_b32 v22, v23
  v_add_f32 v22, v22, v23
  v_mov_b32 v23, v22
  s_nop 1
  v_permlane32_swap_b32 v22, v23
  v_add_f32 v22, v22, v23
  v_mul_f32 v22, 0x3b124925, v22
  v_cvt_pk_bf16_f32 v24, v22, v22
  v_and_b32 v24, 0xffff0000, v24
  v_sub_f32 v22, v22, v24
  v_pk_add_f32 v[32:33], v[32:33], v[24:25] op_sel_hi:[1,0] neg_lo:[0,1] neg_hi:[0,1]
  v_pk_add_f32 v[34:35], v[34:35], v[24:25] op_sel_hi:[1,0] neg_lo:[0,1] neg_hi:[0,1]
  v_pk_add_f32 v[36:37], v[36:37], v[24:25] op_sel_hi:[1,0] neg_lo:[0,1] neg_hi:[0,1]
  v_pk_add_f32 v[38:39], v[38:39], v[24:25] op_sel_hi:[1,0] neg_lo:[0,1] neg_hi:[0,1]
  v_pk_add_f32 v[40:41], v[40:41], v[24:25] op_sel_hi:[1,0] neg_lo:[0,1] neg_hi:[0,1]
  v_pk_add_f32 v[42:43], v[42:43], v[24:25] op_sel_hi:[1,0] neg_lo:[0,1] neg_hi:[0,1]
  v_pk_add_f32 v[44:45], v[44:45], v[24:25] op_sel_hi:[1,0] neg_lo:[0,1] neg_hi:[0,1]
  v_pk_add_f32 v[46:47], v[46:47], v[24:25] op_sel_hi:[1,0] neg_lo:[0,1] neg_hi:[0,1]
  v_pk_add_f32 v[48:49], v[48:49], v[24:25] op_sel_hi:[1,0] neg_lo:[0,1] neg_hi:[0,1]
  v_pk_add_f32 v[50:51], v[50:51], v[24:25] op_sel_hi:[1,0] neg_lo:[0,1] neg_hi:[0,1]
  v_pk_add_f32 v[52:53], v[52:53], v[24:25] op_sel_hi:[1,0] neg_lo:[0,1] neg_hi:[0,1]
  v_pk_add_f32 v[54:55], v[54:55], v[24:25] op_sel_hi:[1,0] neg_lo:[0,1] neg_hi:[0,1]
  v_pk_add_f32 v[56:57], v[56:57], v[24:25] op_sel_hi:[1,0] neg_lo:[0,1] neg_hi:[0,1]
  v_pk_add_f32 v[58:59], v[58:59], v[24:25] op_sel_hi:[1,0] neg_lo:[0,1] neg_hi:[0,1]
  v_pk_mul_f32 v[26:27], v[32:33], v[32:33]
  v_pk_mul_f32 v[24:25], v[34:35], v[34:35]
  v_pk_fma_f32 v[26:27], v[36:37], v[36:37], v[26:27]
  v_pk_fma_f32 v[24:25], v[38:39], v[38:39], v[24:25]
  v_pk_fma_f32 v[26:27], v[40:41], v[40:41], v[26:27]
  v_pk_fma_f32 v[24:25], v[42:43], v[42:43], v[24:25]
  v_pk_fma_f32 v[26:27], v[44:45], v[44:45], v[26:27]
  v_pk_fma_f32 v[24:25], v[46:47], v[46:47], v[24:25]
  v_pk_fma_f32 v[26:27], v[48:49], v[48:49], v[26:27]
  v_pk_fma_f32 v[24:25], v[50:51], v[50:51], v[24:25]
  v_pk_fma_f32 v[26:27], v[52:53], v[52:53], v[26:27]
  v_pk_fma_f32 v[24:25], v[54:55], v[54:55], v[24:25]
  v_pk_fma_f32 v[26:27], v[56:57], v[56:57], v[26:27]
  v_pk_fma_f32 v[24:25], v[58:59], v[58:59], v[24:25]
  v_pk_add_f32 v[26:27], v[26:27], v[24:25]
  v_add_f32 v26, v26, v27
  v_cvt_pk_bf16_f32 v8, v32, v33
  v_cvt_pk_bf16_f32 v9, v34, v35
  v_cvt_pk_bf16_f32 v10, v36, v37
  v_cvt_pk_bf16_f32 v11, v38, v39
  v_cvt_pk_bf16_f32 v12, v40, v41
  v_cvt_pk_bf16_f32 v13, v42, v43
  v_cvt_pk_bf16_f32 v14, v44, v45
  v_cvt_pk_bf16_f32 v15, v46, v47
  v_cvt_pk_bf16_f32 v16, v48, v49
  v_cvt_pk_bf16_f32 v17, v50, v51
  v_cvt_pk_bf16_f32 v18, v52, v53
  v_cvt_pk_bf16_f32 v19, v54, v55
  v_cvt_pk_bf16_f32 v20, v56, v57
  v_cvt_pk_bf16_f32 v21, v58, v59
  v_add_f32_dpp v26, v26, v26 row_ror:4 row_mask:0xf bank_mask:0xf
  s_nop 1
  v_add_f32_dpp v26, v26, v26 row_ror:8 row_mask:0xf bank_mask:0xf
  v_mov_b32 v23, v26
  s_nop 1
  v_permlane16_swap_b32 v26, v23
  v_add_f32 v26, v26, v23
  v_mov_b32 v23, v26
  s_nop 1
  v_permlane32_swap_b32 v26, v23
  v_add_f32 v26, v26, v23
  v_mul_f32 v26, 0x3b124925, v26
  v_fma_f32 v26, -v22, v22, v26
  v_max_f32 v26, 0, v26
  v_cvt_pk_bf16_f32 v26, v26, v26
  v_and_b32 v26, 0xffff0000, v26
  v_add_f32 v26, 0x3727c5ac, v26
  v_cvt_pk_bf16_f32 v26, v26, v26
  v_and_b32 v26, 0xffff0000, v26
  v_sqrt_f32 v26, v26
  s_nop 0
  v_cvt_pk_bf16_f32 v26, v26, v26
  v_and_b32 v26, 0xffff0000, v26
  v_rcp_f32 v26, v26
  v_lshlrev_b32 v32, 16, v8
  v_and_b32 v33, 0xffff0000, v8
  v_lshlrev_b32 v34, 16, v9
  v_and_b32 v35, 0xffff0000, v9
  v_lshlrev_b32 v36, 16, v10
  v_and_b32 v37, 0xffff0000, v10
  v_lshlrev_b32 v38, 16, v11
  v_and_b32 v39, 0xffff0000, v11
  v_lshlrev_b32 v40, 16, v12
  v_and_b32 v41, 0xffff0000, v12
  v_lshlrev_b32 v42, 16, v13
  v_and_b32 v43, 0xffff0000, v13
  v_lshlrev_b32 v44, 16, v14
  v_and_b32 v45, 0xffff0000, v14
  v_lshlrev_b32 v46, 16, v15
  v_and_b32 v47, 0xffff0000, v15
  v_lshlrev_b32 v48, 16, v16
  v_and_b32 v49, 0xffff0000, v16
  v_lshlrev_b32 v50, 16, v17
  v_and_b32 v51, 0xffff0000, v17
  v_lshlrev_b32 v52, 16, v18
  v_and_b32 v53, 0xffff0000, v18
  v_lshlrev_b32 v54, 16, v19
  v_and_b32 v55, 0xffff0000, v19
  v_lshlrev_b32 v56, 16, v20
  v_and_b32 v57, 0xffff0000, v20
  v_lshlrev_b32 v58, 16, v21
  v_and_b32 v59, 0xffff0000, v21
  v_pk_mul_f32 v[32:33], v[32:33], v[26:27] op_sel_hi:[1,0]
  v_pk_mul_f32 v[34:35], v[34:35], v[26:27] op_sel_hi:[1,0]
  v_pk_mul_f32 v[36:37], v[36:37], v[26:27] op_sel_hi:[1,0]
  v_pk_mul_f32 v[38:39], v[38:39], v[26:27] op_sel_hi:[1,0]
  v_pk_mul_f32 v[40:41], v[40:41], v[26:27] op_sel_hi:[1,0]
  v_pk_mul_f32 v[42:43], v[42:43], v[26:27] op_sel_hi:[1,0]
  v_pk_mul_f32 v[44:45], v[44:45], v[26:27] op_sel_hi:[1,0]
  v_pk_mul_f32 v[46:47], v[46:47], v[26:27] op_sel_hi:[1,0]
  v_pk_mul_f32 v[48:49], v[48:49], v[26:27] op_sel_hi:[1,0]
  v_pk_mul_f32 v[50:51], v[50:51], v[26:27] op_sel_hi:[1,0]
  v_pk_mul_f32 v[52:53], v[52:53], v[26:27] op_sel_hi:[1,0]
  v_pk_mul_f32 v[54:55], v[54:55], v[26:27] op_sel_hi:[1,0]
  v_pk_mul_f32 v[56:57], v[56:57], v[26:27] op_sel_hi:[1,0]
  v_pk_mul_f32 v[58:59], v[58:59], v[26:27] op_sel_hi:[1,0]
  v_cvt_pk_bf16_f32 v8, v32, v33
  v_cvt_pk_bf16_f32 v9, v34, v35
  v_cvt_pk_bf16_f32 v10, v36, v37
  v_cvt_pk_bf16_f32 v11, v38, v39
  v_cvt_pk_bf16_f32 v12, v40, v41
  v_cvt_pk_bf16_f32 v13, v42, v43
  v_cvt_pk_bf16_f32 v14, v44, v45
  v_cvt_pk_bf16_f32 v15, v46, v47
  v_cvt_pk_bf16_f32 v16, v48, v49
  v_cvt_pk_bf16_f32 v17, v50, v51
  v_cvt_pk_bf16_f32 v18, v52, v53
  v_cvt_pk_bf16_f32 v19, v54, v55
  v_cvt_pk_bf16_f32 v20, v56, v57
  v_cvt_pk_bf16_f32 v21, v58, v59
  ds_write_b64 v3, v[8:9] offset:0
  ds_write_b64 v3, v[10:11] offset:128
  ds_write_b64 v3, v[12:13] offset:256
  ds_write_b64 v3, v[14:15] offset:384
  ds_write_b64 v3, v[16:17] offset:512
  ds_write_b64 v3, v[18:19] offset:640
  ds_write_b64 v3, v[20:21] offset:768
  ds_read2_b64 v[128:131], v4 offset0:0 offset1:4
  ds_read2_b64 v[132:135], v4 offset0:8 offset1:12
  ds_read2_b64 v[136:139], v4 offset0:16 offset1:20
  ds_read_b64 v[140:141], v4 offset:192
  ds_read2_b64 v[142:145], v5 offset0:0 offset1:4
  ds_read2_b64 v[146:149], v5 offset0:8 offset1:12
  ds_read2_b64 v[150:153], v5 offset0:16 offset1:20
  ds_read_b64 v[154:155], v5 offset:192
  s_waitcnt lgkmcnt(0)
  v_mfma_f32_16x16x32_bf16 v[32:35], v[128:131], v[64:67], 0
  v_mfma_f32_16x16x32_bf16 v[36:39], v[128:131], v[78:81], 0
  v_mfma_f32_16x16x32_bf16 v[40:43], v[128:131], v[92:95], 0
  v_mfma_f32_16x16x32_bf16 v[44:47], v[128:131], v[106:109], 0
  v_mfma_f32_16x16x32_bf16 v[32:35], v[132:135], v[68:71], v[32:35]
  v_mfma_f32_16x16x32_bf16 v[36:39], v[132:135], v[82:85], v[36:39]
  v_mfma_f32_16x16x32_bf16 v[40:43], v[132:135], v[96:99], v[40:43]
  v_mfma_f32_16x16x32_bf16 v[44:47], v[132:135], v[110:113], v[44:47]
  v_mfma_f32_16x16x32_bf16 v[32:35], v[136:139], v[72:75], v[32:35]
  v_mfma_f32_16x16x32_bf16 v[36:39], v[136:139], v[86:89], v[36:39]
  v_mfma_f32_16x16x32_bf16 v[40:43], v[136:139], v[100:103], v[40:43]
  v_mfma_f32_16x16x32_bf16 v[44:47], v[136:139], v[114:117], v[44:47]
  v_mfma_f32_16x16x16_bf16 v[32:35], v[140:141], v[76:77], v[32:35]
  v_mfma_f32_16x16x16_bf16 v[36:39], v[140:141], v[90:91], v[36:39]
  v_mfma_f32_16x16x16_bf16 v[40:43], v[140:141], v[104:105], v[40:43]
  v_mfma_f32_16x16x16_bf16 v[44:47], v[140:141], v[118:119], v[44:47]
  ds_read_b64_tr_b16 v[64:65], v156 offset:14336
  ds_read_b64_tr_b16 v[78:79], v157 offset:14336
  ds_read_b64_tr_b16 v[92:93], v158 offset:14336
  ds_read_b64_tr_b16 v[106:107], v159 offset:14336
  ds_read_b64_tr_b16 v[66:67], v156 offset:16384
  ds_read_b64_tr_b16 v[80:81], v157 offset:16384
  ds_read_b64_tr_b16 v[94:95], v158 offset:16384
  ds_read_b64_tr_b16 v[108:109], v159 offset:16384
  ds_read_b64_tr_b16 v[68:69], v156 offset:18432
  ds_read_b64_tr_b16 v[82:83], v157 offset:18432
  ds_read_b64_tr_b16 v[96:97], v158 offset:18432
  ds_read_b64_tr_b16 v[110:111], v159 offset:18432
  ds_read_b64_tr_b16 v[70:71], v156 offset:20480
  ds_read_b64_tr_b16 v[84:85], v157 offset:20480
  ds_read_b64_tr_b16 v[98:99], v158 offset:20480
  ds_read_b64_tr_b16 v[112:113], v159 offset:20480
  ds_read_b64_tr_b16 v[72:73], v156 offset:22528
  ds_read_b64_tr_b16 v[86:87], v157 offset:22528
  ds_read_b64_tr_b16 v[100:101], v158 offset:22528
  ds_read_b64_tr_b16 v[114:115], v159 offset:22528
  ds_read_b64_tr_b16 v[74:75], v156 offset:24576
  ds_read_b64_tr_b16 v[88:89], v157 offset:24576
  ds_read_b64_tr_b16 v[102:103], v158 offset:24576
  ds_read_b64_tr_b16 v[116:117], v159 offset:24576
  ds_read_b64_tr_b16 v[76:77], v156 offset:26624
  ds_read_b64_tr_b16 v[90:91], v157 offset:26624
  ds_read_b64_tr_b16 v[104:105], v158 offset:26624
  ds_read_b64_tr_b16 v[118:119], v159 offset:26624
  s_mov_b32 s58, 1
  s_movk_i32 s63, 12
L_xc:
  s_waitcnt vmcnt(0)
  v_cmp_ne_u32 vcc, s46, v161
  s_cbranch_vccz L_xc_done
  global_load_dword v161, v160, s[36:37] sc1
  s_sub_u32 s63, s63, 1
  s_cbranch_scc0 L_xc
  s_mov_b32 s58, 0
L_xc_done:
  s_waitcnt lgkmcnt(0)
  v_mfma_f32_16x16x32_bf16 v[48:51], v[142:145], v[64:67], 0
  v_mfma_f32_16x16x32_bf16 v[52:55], v[142:145], v[78:81], 0
  v_mfma_f32_16x16x32_bf16 v[56:59], v[142:145], v[92:95], 0
  v_mfma_f32_16x16x32_bf16 v[60:63], v[142:145], v[106:109], 0
  v_mfma_f32_16x16x32_bf16 v[48:51], v[146:149], v[68:71], v[48:51]
  v_mfma_f32_16x16x32_bf16 v[52:55], v[146:149], v[82:85], v[52:55]
  v_mfma_f32_16x16x32_bf16 v[56:59], v[146:149], v[96:99], v[56:59]
  v_mfma_f32_16x16x32_bf16 v[60:63], v[146:149], v[110:113], v[60:63]
  v_mfma_f32_16x16x32_bf16 v[48:51], v[150:153], v[72:75], v[48:51]
  v_mfma_f32_16x16x32_bf16 v[52:55], v[150:153], v[86:89], v[52:55]
  v_mfma_f32_16x16x32_bf16 v[56:59], v[150:153], v[100:103], v[56:59]
  v_mfma_f32_16x16x32_bf16 v[60:63], v[150:153], v[114:117], v[60:63]
  v_mfma_f32_16x16x16_bf16 v[48:51], v[154:155], v[76:77], v[48:51]
  v_mfma_f32_16x16x16_bf16 v[52:55], v[154:155], v[90:91], v[52:55]
  v_mfma_f32_16x16x16_bf16 v[56:59], v[154:155], v[104:105], v[56:59]
  v_mfma_f32_16x16x16_bf16 v[60:63], v[154:155], v[118:119], v[60:63]
  s_add_u32 s60, s65, 98304
  s_add_u32 s61, s65, 196608
  s_add_u32 s63, s65, 294912
  v_lshlrev_b32 v163, 16, v163
  v_and_b32 v16, 24, v29
  v_lshrrev_b32 v16, v16, v28
  v_and_b32 v17, 16, v7
  v_lshrrev_b32 v17, v17, v28
  v_lshrrev_b32 v18, 8, v17
  s_lshr_b32 s48, s62, 8
  s_lshr_b32 s49, s62, 16
  s_lshr_b32 s50, s62, 24
  s_movk_i32 s51, 0xff00
  v_cndmask_b32 v44, v44, v40, s[12:13]
  v_cndmask_b32 v45, v45, v41, s[12:13]
  v_cndmask_b32 v46, v46, v42, s[12:13]
  v_cndmask_b32 v47, v47, v43, s[12:13]
  v_cndmask_b32 v44, v44, v36, s[10:11]
  v_cndmask_b32 v45, v45, v37, s[10:11]
  v_cndmask_b32 v46, v46, v38, s[10:11]
  v_cndmask_b32 v47, v47, v39, s[10:11]
  v_cndmask_b32 v8, v44, v32, s[8:9]
  v_cndmask_b32 v10, v45, v33, s[8:9]
  v_cndmask_b32 v12, v46, v34, s[8:9]
  v_cndmask_b32 v14, v47, v35, s[8:9]
  v_cndmask_b32 v60, v60, v56, s[12:13]
  v_cndmask_b32 v61, v61, v57, s[12:13]
  v_cndmask_b32 v62, v62, v58, s[12:13]
  v_cndmask_b32 v63, v63, v59, s[12:13]
  v_cndmask_b32 v60, v60, v52, s[10:11]
  v_cndmask_b32 v61, v61, v53, s[10:11]
  v_cndmask_b32 v62, v62, v54, s[10:11]
  v_cndmask_b32 v63, v63, v55, s[10:11]
  v_cndmask_b32 v9, v60, v48, s[8:9]
  v_cndmask_b32 v11, v61, v49, s[8:9]
  v_cndmask_b32 v13, v62, v50, s[8:9]
  v_cndmask_b32 v15, v63, v51, s[8:9]
  s_cmp_lt_u32 s6, 2
  s_cbranch_scc1 L_pubq
  v_bfi_b32 v8, s47, v17, v8
  v_bfi_b32 v9, s47, v18, v9
  v_bfi_b32 v10, s47, v17, v10
  v_bfi_b32 v11, s47, v18, v11
  v_bfi_b32 v12, s47, v17, v12
  v_bfi_b32 v13, s47, v18, v13
  v_bfi_b32 v14, s47, v17, v14
  v_bfi_b32 v15, s47, v18, v15
  s_cmp_eq_u32 s58, 0
  s_cbranch_scc1 L_ss0
  buffer_store_dwordx2 v[8:9], v29, s[40:43], s65 offen
  buffer_store_dwordx2 v[10:11], v29, s[40:43], s60 offen
  buffer_store_dwordx2 v[12:13], v29, s[40:43], s61 offen
  buffer_store_dwordx2 v[14:15], v29, s[40:43], s63 offen
  s_branch L_sd0
L_ss0:
  buffer_store_dwordx2 v[8:9], v29, s[40:43], s65 offen sc1
  buffer_store_dwordx2 v[10:11], v29, s[40:43], s60 offen sc1
  buffer_store_dwordx2 v[12:13], v29, s[40:43], s61 offen sc1
  buffer_store_dwordx2 v[14:15], v29, s[40:43], s63 offen sc1
L_sd0:
  s_branch L_pubd
L_pubq:
  v_add_f32 v8, v8, v9
  v_add_f32 v10, v10, v11
  v_add_f32 v12, v12, v13
  v_add_f32 v14, v14, v15
  v_bfi_b32 v8, s47, v16, v8
  v_bfi_b32 v10, s47, v16, v10
  v_bfi_b32 v12, s47, v16, v12
  v_bfi_b32 v14, s47, v16, v14
  s_cmp_eq_u32 s58, 0
  s_cbranch_scc1 L_ss1
  buffer_store_dword v8, v6, s[40:43], s65 offen
  buffer_store_dword v10, v6, s[40:43], s60 offen
  buffer_store_dword v12, v6, s[40:43], s61 offen
  buffer_store_dword v14, v6, s[40:43], s63 offen
  s_branch L_sd1
L_ss1:
  buffer_store_dword v8, v6, s[40:43], s65 offen sc1
  buffer_store_dword v10, v6, s[40:43], s60 offen sc1
  buffer_store_dword v12, v6, s[40:43], s61 offen sc1
  buffer_store_dword v14, v6, s[40:43], s63 offen sc1
L_sd1:
L_pubd:
  s_mov_b32 s63, 400000
  s_waitcnt vmcnt(0)
  s_branch L_gq_go
L_gq:
  s_sleep 32
L_gq_go:
  buffer_load_dwordx4 v[32:35], v7, s[40:43], s67 offen offset:0 sc1
  buffer_load_dwordx4 v[36:39], v7, s[40:43], s67 offen offset:1024 sc1
  buffer_load_dwordx4 v[40:43], v7, s[40:43], s67 offen offset:2048 sc1
  buffer_load_dwordx4 v[44:47], v7, s[40:43], s67 offen offset:3072 sc1
  s_sub_u32 s63, s63, 1
  s_waitcnt vmcnt(0)
  s_cbranch_scc1 L_gq_done
  v_xor_b32 v24, s62, v32
  v_xor_b32 v25, s48, v33
  v_bitop3_b32 v24, v34, s49, v24 bitop3:0xbe
  v_bitop3_b32 v25, v35, s50, v25 bitop3:0xbe
  v_bitop3_b32 v24, v36, s62, v24 bitop3:0xbe
  v_bitop3_b32 v25, v37, s48, v25 bitop3:0xbe
  v_bitop3_b32 v24, v38, s49, v24 bitop3:0xbe
  v_bitop3_b32 v25, v39, s50, v25 bitop3:0xbe
  v_bitop3_b32 v24, v40, s62, v24 bitop3:0xbe
  v_bitop3_b32 v25, v41, s48, v25 bitop3:0xbe
  v_bitop3_b32 v24, v42, s49, v24 bitop3:0xbe
  v_bitop3_b32 v25, v43, s50, v25 bitop3:0xbe
  v_bitop3_b32 v24, v44, s62, v24 bitop3:0xbe
  v_bitop3_b32 v25, v45, s48, v25 bitop3:0xbe
  v_bitop3_b32 v24, v46, s49, v24 bitop3:0xbe
  v_bitop3_b32 v25, v47, s50, v25 bitop3:0xbe
  v_or_b32 v24, v24, v25
  v_and_b32 v24, s47, v24
  v_cmp_ne_u32 vcc, 0, v24
  s_cbranch_vccnz L_gq
L_gq_done:
  v_and_b32 v32, s51, v32
  v_and_b32 v33, s51, v33
  v_and_b32 v34, s51, v34
  v_and_b32 v35, s51, v35
  v_and_b32 v36, s51, v36
  v_and_b32 v37, s51, v37
  v_and_b32 v38, s51, v38
  v_and_b32 v39, s51, v39
  v_and_b32 v40, s51, v40
  v_and_b32 v41, s51, v41
  v_and_b32 v42, s51, v42
  v_and_b32 v43, s51, v43
  v_and_b32 v44, s51, v44
  v_and_b32 v45, s51, v45
  v_and_b32 v46, s51, v46
  v_and_b32 v47, s51, v47
  v_pk_add_f32 v[32:33], v[32:33], v[40:41]
  v_pk_add_f32 v[34:35], v[34:35], v[42:43]
  v_pk_add_f32 v[36:37], v[36:37], v[44:45]
  v_pk_add_f32 v[38:39], v[38:39], v[46:47]
  v_add_u32 v24, 148480, v29
  v_cvt_pk_bf16_f32 v8, v32, v33
  v_cvt_pk_bf16_f32 v9, v34, v35
  v_cvt_pk_bf16_f32 v10, v36, v37
  v_cvt_pk_bf16_f32 v11, v38, v39
  ds_write_b64 v24, v[8:9]
  ds_write_b64 v24, v[10:11] offset:512
  ds_write_b32 v31, v30 offset:0
  v_mov_b32 v27, v28
  s_add_u32 s60, s67, 4096
  s_add_u32 s61, s67, 8192
  s_mov_b32 s63, 400000
  s_branch L_gh_go
L_gh:
  s_sleep 32
L_gh_go:
  buffer_load_dwordx4 v[32:35], v7, s[40:43], s60 offen offset:0 sc1
  buffer_load_dwordx4 v[36:39], v7, s[40:43], s60 offen offset:1024 sc1
  buffer_load_dwordx4 v[40:43], v7, s[40:43], s60 offen offset:2048 sc1
  buffer_load_dwordx4 v[44:47], v7, s[40:43], s60 offen offset:3072 sc1
  buffer_load_dwordx4 v[48:51], v7, s[40:43], s61 offen offset:0 sc1
  buffer_load_dwordx4 v[52:55], v7, s[40:43], s61 offen offset:1024 sc1
  buffer_load_dwordx4 v[56:59], v7, s[40:43], s61 offen offset:2048 sc1
  buffer_load_dwordx4 v[60:63], v7, s[40:43], s61 offen offset:3072 sc1
  s_sub_u32 s63, s63, 1
  s_waitcnt vmcnt(0)
  s_cbranch_scc1 L_gh_done
  v_xor_b32 v24, s62, v32
  v_xor_b32 v25, s48, v33
  v_bitop3_b32 v24, v34, s49, v24 bitop3:0xbe
  v_bitop3_b32 v25, v35, s50, v25 bitop3:0xbe
  v_bitop3_b32 v24, v36, s62, v24 bitop3:0xbe
  v_bitop3_b32 v25, v37, s48, v25 bitop3:0xbe
  v_bitop3_b32 v24, v38, s49, v24 bitop3:0xbe
  v_bitop3_b32 v25, v39, s50, v25 bitop3:0xbe
  v_bitop3_b32 v24, v40, s62, v24 bitop3:0xbe
  v_bitop3_b32 v25, v41, s48, v25 bitop3:0xbe
  v_bitop3_b32 v24, v42, s49, v24 bitop3:0xbe
  v_bitop3_b32 v25, v43, s50, v25 bitop3:0xbe
  v_bitop3_b32 v24, v44, s62, v24 bitop3:0xbe
  v_bitop3_b32 v25, v45, s48, v25 bitop3:0xbe
  v_bitop3_b32 v24, v46, s49, v24 bitop3:0xbe
  v_bitop3_b32 v25, v47, s50, v25 bitop3:0xbe
  v_bitop3_b32 v24, v48, s62, v24 bitop3:0xbe
  v_bitop3_b32 v25, v49, s48, v25 bitop3:0xbe
  v_bitop3_b32 v24, v50, s49, v24 bitop3:0xbe
  v_bitop3_b32 v25, v51, s50, v25 bitop3:0xbe
  v_bitop3_b32 v24, v52, s62, v24 bitop3:0xbe
  v_bitop3_b32 v25, v53, s48, v25 bitop3:0xbe
  v_bitop3_b32 v24, v54, s49, v24 bitop3:0xbe
  v_bitop3_b32 v25, v55, s50, v25 bitop3:0xbe
  v_bitop3_b32 v24, v56, s62, v24 bitop3:0xbe
  v_bitop3_b32 v25, v57, s48, v25 bitop3:0xbe
  v_bitop3_b32 v24, v58, s49, v24 bitop3:0xbe
  v_bitop3_b32 v25, v59, s50, v25 bitop3:0xbe
  v_bitop3_b32 v24, v60, s62, v24 bitop3:0xbe
  v_bitop3_b32 v25, v61, s48, v25 bitop3:0xbe
  v_bitop3_b32 v24, v62, s49, v24 bitop3:0xbe
  v_bitop3_b32 v25, v63, s50, v25 bitop3:0xbe
  v_or_b32 v24, v24, v25
  v_and_b32 v24, s47, v24
  v_cmp_ne_u32 vcc, 0, v24
  s_cbranch_vccnz L_gh
L_gh_done:
  v_and_b32 v32, s51, v32
  v_and_b32 v33, s51, v33
  v_and_b32 v34, s51, v34
  v_and_b32 v35, s51, v35
  v_and_b32 v36, s51, v36
  v_and_b32 v37, s51, v37
  v_and_b32 v38, s51, v38
  v_and_b32 v39, s51, v39
  v_and_b32 v40, s51, v40
  v_and_b32 v41, s51, v41
  v_and_b32 v42, s51, v42
  v_and_b32 v43, s51, v43
  v_and_b32 v44, s51, v44
  v_and_b32 v45, s51, v45
  v_and_b32 v46, s51, v46
  v_and_b32 v47, s51, v47
  v_and_b32 v48, s51, v48
  v_and_b32 v49, s51, v49
  v_and_b32 v50, s51, v50
  v_and_b32 v51, s51, v51
  v_and_b32 v52, s51, v52
  v_and_b32 v53, s51, v53
  v_and_b32 v54, s51, v54
  v_and_b32 v55, s51, v55
  v_and_b32 v56, s51, v56
  v_and_b32 v57, s51, v57
  v_and_b32 v58, s51, v58
  v_and_b32 v59, s51, v59
  v_and_b32 v60, s51, v60
  v_and_b32 v61, s51, v61
  v_and_b32 v62, s51, v62
  v_and_b32 v63, s51, v63
  v_pk_add_f32 v[32:33], v[32:33], v[40:41]
  v_pk_add_f32 v[48:49], v[48:49], v[56:57]
  v_pk_add_f32 v[34:35], v[34:35], v[42:43]
  v_pk_add_f32 v[50:51], v[50:51], v[58:59]
  v_pk_add_f32 v[36:37], v[36:37], v[44:45]
  v_pk_add_f32 v[52:53], v[52:53], v[60:61]
  v_pk_add_f32 v[38:39], v[38:39], v[46:47]
  v_pk_add_f32 v[54:55], v[54:55], v[62:63]
  v_pk_add_f32 v[32:33], v[32:33], v[48:49]
  v_pk_add_f32 v[34:35], v[34:35], v[50:51]
  v_pk_add_f32 v[36:37], v[36:37], v[52:53]
  v_pk_add_f32 v[38:39], v[38:39], v[54:55]
  v_cvt_pk_bf16_f32 v33, v32, v33
  v_lshlrev_b32 v32, 16, v33
  v_and_b32 v33, 0xffff0000, v33
  v_max_f32 v32, 0, v32
  v_mul_f32 v32, v32, v33
  v_cvt_pk_bf16_f32 v35, v34, v35
  v_lshlrev_b32 v34, 16, v35
  v_and_b32 v35, 0xffff0000, v35
  v_max_f32 v34, 0, v34
  v_mul_f32 v34, v34, v35
  v_cvt_pk_bf16_f32 v37, v36, v37
  v_lshlrev_b32 v36, 16, v37
  v_and_b32 v37, 0xffff0000, v37
  v_max_f32 v36, 0, v36
  v_mul_f32 v36, v36, v37
  v_cvt_pk_bf16_f32 v39, v38, v39
  v_lshlrev_b32 v38, 16, v39
  v_and_b32 v39, 0xffff0000, v39
  v_max_f32 v38, 0, v38
  v_mul_f32 v38, v38, v39
  v_cvt_pk_bf16_f32 v8, v32, v34
  v_cvt_pk_bf16_f32 v9, v36, v38
  v_add_u32 v24, 147968, v6
  ds_write2st64_b32 v24, v8, v9 offset0:0 offset1:1
  v_mov_b32 v32, -1
  v_mov_b32 v33, -1
  v_mov_b32 v34, -1
  v_mov_b32 v35, -1
  s_cmp_eq_u32 s5, 7
  s_cbranch_scc1 L_notk
  s_lshl3_add_u32 s60, s64, s4
  s_lshl_b32 s60, s60, 8
  s_add_u32 s60, s60, 1835008
  s_cmp_lg_u32 s4, 0
  s_cbranch_scc1 L_notk
  s_lshl_b32 s60, s64, 7
  s_add_u32 s60, s60, 12288
  v_mov_b32 v26, 0
  s_mov_b64 exec, 1
  buffer_store_dwordx2 v[26:27], v6, s[40:43], s60 offen sc1
  s_mov_b64 exec, -1
L_notk:
  s_lshl3_add_u32 s60, s56, s5
  s_lshl_b32 s60, s60, 10
  s_add_u32 s60, s60, 262144
  s_cmp_eq_u32 s58, 0
  s_cbranch_scc1 L_ss2
  buffer_store_dwordx4 v[32:35], v7, s[40:43], s60 offen
  s_branch L_sd2
L_ss2:
  buffer_store_dwordx4 v[32:35], v7, s[40:43], s60 offen sc1
L_sd2:
  s_waitcnt vmcnt(0)
  s_mov_b32 s63, 3200000
L_wc:
  ds_read_b32 v9, v31 offset:4
  s_sub_u32 s63, s63, 1
  s_waitcnt lgkmcnt(0)
  s_cbranch_scc1 L_wc_done
  v_cmp_le_u32 vcc, 8, v9
  s_cbranch_vccnz L_wc_done
  s_sleep 4
  s_branch L_wc
L_wc_done:
  v_lshlrev_b32 v8, 3, v2
  v_add_u32 v8, 147456, v8
  ds_read_b64 v[4:5], v8
  s_lshl4_add_u32 s61, s5, s7
  v_mov_b32 v25, v28
  s_waitcnt lgkmcnt(0)
  v_max_f32_dpp v24, v4, v4 quad_perm:[1,0,3,2] row_mask:0xf bank_mask:0xf
  s_nop 1
  v_max_f32_dpp v24, v24, v24 quad_perm:[2,3,0,1] row_mask:0xf bank_mask:0xf
  s_nop 1
  v_max_f32_dpp v24, v24, v24 row_half_mirror row_mask:0xf bank_mask:0xf
  v_sub_f32 v26, v4, v24
  v_mul_f32 v26, 0x3db8aa3b, v26
  v_exp_f32 v26, v26
  s_nop 0
  v_mul_f32 v26, v26, v5
  s_nop 1
  v_add_f32_dpp v26, v26, v26 quad_perm:[1,0,3,2] row_mask:0xf bank_mask:0xf
  s_nop 1
  v_add_f32_dpp v26, v26, v26 quad_perm:[2,3,0,1] row_mask:0xf bank_mask:0xf
  s_nop 1
  v_add_f32_dpp v26, v26, v26 row_half_mirror row_mask:0xf bank_mask:0xf
  s_mov_b64 exec, 0x101
  s_cmp_eq_u32 s58, 0
  s_cbranch_scc1 L_ss3
  buffer_store_dwordx4 v[24:27], v7, s[40:43], s61 offen
  s_branch L_sd3
L_ss3:
  buffer_store_dwordx4 v[24:27], v7, s[40:43], s61 offen sc1
L_sd3:
  s_mov_b64 exec, 0xffff
  s_mov_b32 s63, 400000
  s_branch L_polls_go
L_polls:
  s_sleep 32
L_polls_go:
  buffer_load_dwordx4 v[16:19], v7, s[40:43], s7 offen sc1
  s_sub_u32 s63, s63, 1
  s_waitcnt vmcnt(0)
  s_cbranch_scc1 L_polls_done
  v_min3_u32 v10, v17, v19, v28
  v_max3_u32 v11, v17, v19, v28
  v_cmp_ne_u32 vcc, v10, v11
  s_cbranch_vccnz L_polls
L_polls_done:
  v_max_f32_dpp v10, v16, v16 quad_perm:[1,0,3,2] row_mask:0xf bank_mask:0xf
  s_nop 1
  v_max_f32_dpp v10, v10, v10 quad_perm:[2,3,0,1] row_mask:0xf bank_mask:0xf
  s_nop 1
  v_max_f32_dpp v10, v10, v10 row_half_mirror row_mask:0xf bank_mask:0xf
  v_sub_f32 v11, v16, v10
  v_sub_f32 v10, v4, v10
  v_mul_f32 v11, 0x3db8aa3b, v11
  v_mul_f32 v10, 0x3db8aa3b, v10
  v_exp_f32 v11, v11
  v_exp_f32 v10, v10
  v_mul_f32 v11, v11, v18
  s_nop 1
  v_add_f32_dpp v11, v11, v11 quad_perm:[1,0,3,2] row_mask:0xf bank_mask:0xf
  s_nop 1
  v_add_f32_dpp v11, v11, v11 quad_perm:[2,3,0,1] row_mask:0xf bank_mask:0xf
  s_nop 1
  v_add_f32_dpp v11, v11, v11 row_half_mirror row_mask:0xf bank_mask:0xf
  v_rcp_f32 v11, v11
  s_nop 0
  v_mul_f32 v10, v10, v11
  v_and_b32 v9, 56, v29
  v_lshrrev_b32 v8, 1, v0
  v_and_b32 v8, 4, v8
  v_add3_u32 v9, v9, v8, v31
  v_subrev_u32 v9, 12160, v9
  ds_write_b32 v9, v10
  s_mov_b64 exec, -1
  v_mov_b32 v24, 1
  v_mov_b32 v25, s58
  v_mov_b32 v26, v28
  ds_write_b128 v31, v[24:27] offset:16
  s_cmp_eq_u32 s5, 7
  s_waitcnt lgkmcnt(0)
  s_cbranch_scc1 L_hdone
  v_mov_b32 v4, v162
  v_mov_b32 v5, v163
  s_mov_b64 s[52:53], s[34:35]
  s_movk_i32 s54, 3584
  s_mov_b32 s55, 0x20000
  s_lshl_b32 s60, s64, 11
  s_add_u32 s60, s60, 1835008
  v_add_u32 v6, s60, v6
  v_lshlrev_b32 v7, 2, v0
  v_add_u32 v7, 149504, v7
  s_xor_b32 s19, s4, 1
  s_lshl_b32 s19, s19, 8
  s_xor_b32 s20, s4, 2
  s_lshl_b32 s20, s20, 8
  s_xor_b32 s21, s4, 3
  s_lshl_b32 s21, s21, 8
  s_xor_b32 s22, s4, 4
  s_lshl_b32 s22, s22, 8
  s_xor_b32 s23, s4, 5
  s_lshl_b32 s23, s23, 8
  s_xor_b32 s24, s4, 6
  s_lshl_b32 s24, s24, 8
  s_xor_b32 s25, s4, 7
  s_lshl_b32 s25, s25, 8
  s_lshl_b32 s60, s56, 13
  s_add_u32 s60, s60, 270208
  v_lshl_add_u32 v57, v0, 3, s60
  s_lshl_b32 s60, s64, 7
  s_add_u32 s60, s60, 12288
  s_add_u32 s32, s38, s60
  s_addc_u32 s33, s39, 0
  s_mov_b32 s63, 400000
L_tkw:
  s_load_dwordx2 s[28:29], s[32:33], 0 glc
  s_sub_u32 s63, s63, 1
  s_waitcnt lgkmcnt(0)
  s_cbranch_scc1 L_tkw_done
  s_cmp_eq_u32 s29, s62
  s_cbranch_scc1 L_tkw_done
  s_sleep 32
  s_branch L_tkw
L_tkw_done:
  s_mov_b32 s30, 1
  s_mov_b32 s63, 400000
  s_mov_b64 exec, 0xffff
  s_barrier
L_trig:
  s_load_dword s28, s[32:33], 0 glc
  buffer_load_dword v61, v57, s[40:43], 0 offen sc1
  s_waitcnt vmcnt(0)
  v_cmp_eq_u32 vcc, -1, v61
  s_cbranch_vccz L_trig_done
  buffer_load_dword v61, v57, s[40:43], 0 offen sc1
  s_waitcnt vmcnt(0)
  v_cmp_eq_u32 vcc, -1, v61
  s_cbranch_vccz L_trig_done
  buffer_load_dword v61, v57, s[40:43], 0 offen sc1
  s_waitcnt vmcnt(0)
  v_cmp_eq_u32 vcc, -1, v61
  s_cbranch_vccz L_trig_done
  s_waitcnt lgkmcnt(0)
  s_cmp_eq_u32 s28, 7
  s_cbranch_scc1 L_sure
  s_sub_u32 s63, s63, 1
  s_cbranch_scc0 L_trig
L_trig_done:
  s_atomic_add s30, s[32:33], 0 glc
  s_mov_b64 exec, -1
L_b5:
  s_barrier
  ds_read2st64_b32 v[48:49], v7 offset0:0 offset1:1
  ds_read2st64_b32 v[50:51], v7 offset0:2 offset1:3
  ds_read2st64_b32 v[52:53], v7 offset0:4 offset1:5
  ds_read2st64_b32 v[54:55], v7 offset0:6 offset1:7
  s_mov_b32 s63, 400000
  s_waitcnt lgkmcnt(0)
  s_cmp_lt_u32 s30, 7
  s_cbranch_scc1 L_hdone
  s_cmp_eq_u32 s30, 8
  s_cbranch_scc1 L_adds
  buffer_load_dword v34, v6, s[40:43], s19 offen sc1
  buffer_load_dword v36, v6, s[40:43], s20 offen sc1
  buffer_load_dword v38, v6, s[40:43], s21 offen sc1
  buffer_load_dword v40, v6, s[40:43], s22 offen sc1
  buffer_load_dword v42, v6, s[40:43], s23 offen sc1
  buffer_load_dword v44, v6, s[40:43], s24 offen sc1
  buffer_load_dword v46, v6, s[40:43], s25 offen sc1
L_adds:
  v_add_f32 v48, v48, v49
  v_add_f32 v50, v50, v51
  v_add_f32 v52, v52, v53
  v_add_f32 v54, v54, v55
  v_add_f32 v48, v48, v50
  v_add_f32 v52, v52, v54
  v_add_f32 v26, v48, v52
L_fchk:
  s_sub_u32 s63, s63, 1
  s_waitcnt vmcnt(0)
  s_cbranch_scc1 L_fsum
  v_max3_u32 v12, v34, v36, v38
  v_max3_u32 v13, v40, v42, v44
  v_max3_u32 v12, v12, v13, v46
  v_cmp_eq_u32 vcc, -1, v12
  s_cbranch_vccnz L_fpoll
L_fsum:
  v_add_f32 v34, v34, v26
  v_add_f32 v36, v36, v38
  v_add_f32 v40, v40, v42
  v_add_f32 v44, v44, v46
  v_add_f32 v34, v34, v36
  v_add_f32 v40, v40, v44
L_finish:
  v_add_f32 v34, v34, v40
  v_add_f32 v34, v34, v5
  v_cvt_pk_bf16_f32 v34, v34, v34
  buffer_store_short v34, v4, s[52:55], 0 offen
  s_cmp_lg_u32 s64, 21
  s_cbranch_scc1 L_hdone
  s_mov_b64 exec, 1
  v_mov_b32 v1, 0
  buffer_store_dword v28, v1, s[40:43], 0 offen
L_hdone:
L_end:
  s_endpgm
L_fpoll:
  buffer_load_dword v34, v6, s[40:43], s19 offen sc1
  buffer_load_dword v36, v6, s[40:43], s20 offen sc1
  buffer_load_dword v38, v6, s[40:43], s21 offen sc1
  buffer_load_dword v40, v6, s[40:43], s22 offen sc1
  buffer_load_dword v42, v6, s[40:43], s23 offen sc1
  buffer_load_dword v44, v6, s[40:43], s24 offen sc1
  buffer_load_dword v46, v6, s[40:43], s25 offen sc1
  s_branch L_fchk
L_sure:
  ds_write_b32 v31, v30 offset:44
  s_mov_b32 s30, 8
L_trig2:
  buffer_load_dword v61, v57, s[40:43], 0 offen sc1
  s_waitcnt vmcnt(0)
  v_cmp_eq_u32 vcc, -1, v61
  s_cbranch_vccz L_trig2_done
  s_sub_u32 s63, s63, 1
  s_cbranch_scc0 L_trig2
L_trig2_done:
  s_mov_b64 exec, -1
  buffer_load_dword v34, v6, s[40:43], s19 offen sc1
  buffer_load_dword v36, v6, s[40:43], s20 offen sc1
  buffer_load_dword v38, v6, s[40:43], s21 offen sc1
  buffer_load_dword v40, v6, s[40:43], s22 offen sc1
  buffer_load_dword v42, v6, s[40:43], s23 offen sc1
  buffer_load_dword v44, v6, s[40:43], s24 offen sc1
  buffer_load_dword v46, v6, s[40:43], s25 offen sc1
  s_waitcnt lgkmcnt(0)
  s_branch L_b5
L_stream:
  s_barrier
  s_add_u32 s12, s20, s57
  s_addc_u32 s13, s21, 0
  s_mov_b64 s[14:15], s[10:11]
  s_mov_b64 s[40:41], s[38:39]
  s_mov_b32 s42, 1966080
  s_mov_b32 s43, s11
  v_mov_b32 v26, 159744
  s_getreg_b32 s60, hwreg(HW_REG_XCC_ID, 0, 3)
  s_bitcmp1_b32 85, s60
  s_cselect_b64 vcc, -1, 0
  s_waitcnt vmcnt(5)
  s_xor_b32 m0, s59, 4096
  s_xor_b32 s60, s58, 4096
  buffer_load_dwordx4 v4, s[8:11], s60 offen offset:0 nt lds
  buffer_load_dwordx4 v5, s[8:11], s60 offen offset:1024 nt lds
  buffer_load_dwordx4 v6, s[8:11], s60 offen offset:2048 nt lds
  buffer_load_dwordx4 v7, s[8:11], s60 offen offset:3072 nt lds
  s_mov_b64 s[52:53], s[24:25]
  s_mov_b64 s[48:49], s[32:33]
  s_mov_b32 s51, s11
  s_mov_b32 s55, s11
  s_cmp_lt_u32 s5, 7
  s_cselect_b32 s54, 3670016, 0
  s_cselect_b32 s61, s5, 0
  s_lshl_b32 s61, s61, 7
  s_lshl4_add_u32 s64, s4, s3
  s_mul_i32 s64, s64, 28672
  s_add_u32 s64, s64, s61
  s_lshl3_add_u32 s65, s4, s3
  s_mul_i32 s65, s65, 28672
  s_add_u32 s65, s65, s61
  s_cmp_lt_u32 s7, 7
  s_cselect_b32 s50, 1605632, 0
  s_cselect_b32 s65, s65, 0
  v_and_b32 v1, 15, v0
  v_lshrrev_b32 v2, 4, v0
  v_and_b32 v3, 7, v0
  v_lshlrev_b32 v3, 1, v3
  v_xor_b32 v3, v3, v2
  v_lshlrev_b32 v3, 4, v3
  v_lshl_add_u32 v3, v1, 9, v3
  v_add_u32 v8, s59, v3
  v_xor_b32 v9, 64, v8
  v_xor_b32 v10, 0x80, v8
  v_xor_b32 v11, 0xc0, v8
  s_waitcnt vmcnt(4)
  s_mov_b64 exec, 1
  ds_add_u32 v26, v28 offset:12
  s_mov_b64 exec, -1
  s_waitcnt vmcnt(1)
  s_xor_b32 m0, s59, 8192
  s_xor_b32 s60, s58, 524288
  buffer_load_dwordx4 v4, s[8:11], s60 offen offset:0 nt lds
  buffer_load_dwordx4 v5, s[8:11], s60 offen offset:1024 nt lds
  buffer_load_dwordx4 v6, s[8:11], s60 offen offset:2048 nt lds
  buffer_load_dwordx4 v7, s[8:11], s60 offen offset:3072 nt lds
  s_waitcnt vmcnt(4)
  ds_read_b128 v[32:35], v8 offset:0
  ds_read_b128 v[36:39], v9 offset:0
  ds_read_b128 v[40:43], v10 offset:0
  ds_read_b128 v[44:47], v11 offset:0
  ds_read_b128 v[48:51], v8 offset:256
  ds_read_b128 v[52:55], v9 offset:256
  ds_read_b128 v[56:59], v10 offset:256
  ds_read_b128 v[60:63], v11 offset:256
  v_lshrrev_b32 v21, 2, v0
  v_and_b32 v22, 7, v21
  v_lshlrev_b32 v22, 5, v22
  v_lshl_add_u32 v22, v21, 9, v22
  v_and_b32 v23, 3, v0
  v_lshl_add_u32 v22, v23, 3, v22
  v_add_u32 v12, s59, v22
  v_xor_b32 v13, 32, v12
  v_xor_b32 v14, 64, v12
  v_xor_b32 v15, 96, v12
  v_xor_b32 v16, 128, v12
  v_xor_b32 v17, 160, v12
  v_xor_b32 v18, 192, v12
  v_xor_b32 v19, 224, v12
  v_and_b32 v24, 1, v0
  v_lshlrev_b32 v25, 6, v24
  v_lshlrev_b32 v24, 9, v24
  v_lshl_add_u32 v24, v2, 4, v24
  v_add_u32 v24, 148480, v24
  s_lshl_b32 s60, s3, 3
  s_add_u32 s60, s60, 147456
  v_add_u32 v25, s60, v25
  s_waitcnt vmcnt(1)
  s_xor_b32 m0, s59, 12288
  s_xor_b32 s60, s58, 528384
  s_cbranch_vccz L_fK110
  s_waitcnt vmcnt(1)
L_fK110:
  buffer_load_dwordx4 v4, s[8:11], s60 offen offset:0 nt lds
  buffer_load_dwordx4 v5, s[8:11], s60 offen offset:1024 nt lds
  s_cbranch_vccz L_fK112
  s_waitcnt vmcnt(1)
L_fK112:
  buffer_load_dwordx4 v6, s[8:11], s60 offen offset:2048 nt lds
  buffer_load_dwordx4 v7, s[8:11], s60 offen offset:3072 nt lds
  s_waitcnt lgkmcnt(0)
  s_waitcnt vmcnt(1)
  s_xor_b32 m0, s59, 0
  s_xor_b32 s60, s58, 1048576
  s_cbranch_vccz L_fK200
  s_waitcnt vmcnt(1)
L_fK200:
  buffer_load_dwordx4 v4, s[8:11], s60 offen offset:0 nt lds
  buffer_load_dwordx4 v5, s[8:11], s60 offen offset:1024 nt lds
  s_cbranch_vccz L_fK202
  s_waitcnt vmcnt(1)
L_fK202:
  buffer_load_dwordx4 v6, s[8:11], s60 offen offset:2048 nt lds
  buffer_load_dwordx4 v7, s[8:11], s60 offen offset:3072 nt lds
  s_waitcnt vmcnt(4)
  ds_read_b128 v[64:67], v8 offset:8192
  ds_read_b128 v[68:71], v9 offset:8192
  ds_read_b128 v[72:75], v10 offset:8192
  ds_read_b128 v[76:79], v11 offset:8192
  ds_read_b128 v[80:83], v8 offset:8448
  ds_read_b128 v[84:87], v9 offset:8448
  ds_read_b128 v[88:91], v10 offset:8448
  ds_read_b128 v[92:95], v11 offset:8448
  s_waitcnt vmcnt(1)
  s_xor_b32 m0, s59, 4096
  s_xor_b32 s60, s58, 1052672
  s_cbranch_vccz L_fK210
  s_waitcnt vmcnt(1)
L_fK210:
  buffer_load_dwordx4 v4, s[8:11], s60 offen offset:0 nt lds
  buffer_load_dwordx4 v5, s[8:11], s60 offen offset:1024 nt lds
  s_cbranch_vccz L_fK212
  s_waitcnt vmcnt(1)
L_fK212:
  buffer_load_dwordx4 v6, s[8:11], s60 offen offset:2048 nt lds
  buffer_load_dwordx4 v7, s[8:11], s60 offen offset:3072 nt lds
  s_waitcnt lgkmcnt(0)
  s_waitcnt vmcnt(1)
  s_xor_b32 m0, s59, 8192
  s_xor_b32 s60, s58, 1572864
  buffer_load_dwordx4 v4, s[8:11], s60 offen offset:0 nt lds
  buffer_load_dwordx4 v5, s[8:11], s60 offen offset:1024 nt lds
  buffer_load_dwordx4 v6, s[8:11], s60 offen offset:2048 nt lds
  buffer_load_dwordx4 v7, s[8:11], s60 offen offset:3072 nt lds
  s_waitcnt vmcnt(4)
  ds_read_b128 v[96:99], v8 offset:0
  ds_read_b128 v[100:103], v9 offset:0
  ds_read_b128 v[104:107], v10 offset:0
  ds_read_b128 v[108:111], v11 offset:0
  ds_read_b128 v[112:115], v8 offset:256
  ds_read_b128 v[116:119], v9 offset:256
  ds_read_b128 v[120:123], v10 offset:256
  ds_read_b128 v[124:127], v11 offset:256
  s_waitcnt vmcnt(1)
  s_xor_b32 m0, s59, 12288
  s_xor_b32 s60, s58, 1576960
  buffer_load_dwordx4 v4, s[8:11], s60 offen offset:0 nt lds
  buffer_load_dwordx4 v5, s[8:11], s60 offen offset:1024 nt lds
  buffer_load_dwordx4 v6, s[8:11], s60 offen offset:2048 nt lds
  buffer_load_dwordx4 v7, s[8:11], s60 offen offset:3072 nt lds
  s_waitcnt lgkmcnt(0)
  s_waitcnt vmcnt(1)
  s_xor_b32 m0, s59, 0
  s_xor_b32 s60, s58, 0
  buffer_load_dwordx4 v4, s[12:15], s60 offen offset:0 nt lds
  buffer_load_dwordx4 v5, s[12:15], s60 offen offset:1024 nt lds
  buffer_load_dwordx4 v6, s[12:15], s60 offen offset:2048 nt lds
  buffer_load_dwordx4 v7, s[12:15], s60 offen offset:3072 nt lds
  s_waitcnt vmcnt(4)
  s_waitcnt vmcnt(1)
  s_xor_b32 m0, s59, 4096
  s_xor_b32 s60, s58, 4096
  buffer_load_dwordx4 v4, s[12:15], s60 offen offset:0 nt lds
  buffer_load_dwordx4 v5, s[12:15], s60 offen offset:1024 nt lds
  buffer_load_dwordx4 v6, s[12:15], s60 offen offset:2048 nt lds
  buffer_load_dwordx4 v7, s[12:15], s60 offen offset:3072 nt lds
  s_mov_b32 s61, 3200000
L_wq:
  ds_read_b32 v1, v26 offset:0
  s_sub_u32 s61, s61, 1
  s_waitcnt lgkmcnt(0)
  s_cbranch_scc1 L_wq_done
  v_readfirstlane_b32 s67, v1
  s_cmp_lg_u32 s67, 0
  s_cbranch_scc1 L_wq_done
  s_sleep 1
  s_branch L_wq
L_wq_done:
  ds_read_b128 v[144:147], v24 offset:0
  ds_read_b128 v[148:151], v24 offset:64
  ds_read_b128 v[152:155], v24 offset:128
  ds_read_b128 v[156:159], v24 offset:192
  ds_read_b128 v[160:163], v24 offset:256
  ds_read_b128 v[164:167], v24 offset:320
  s_waitcnt lgkmcnt(2)
  v_mfma_f32_16x16x32_bf16 v[128:131], v[32:35], v[144:147], 0
  v_mfma_f32_16x16x32_bf16 v[128:131], v[36:39], v[148:151], v[128:131]
  v_mfma_f32_16x16x32_bf16 v[128:131], v[40:43], v[152:155], v[128:131]
  v_mfma_f32_16x16x32_bf16 v[128:131], v[44:47], v[156:159], v[128:131]
  v_mfma_f32_16x16x32_bf16 v[132:135], v[64:67], v[144:147], 0
  v_mfma_f32_16x16x32_bf16 v[132:135], v[68:71], v[148:151], v[132:135]
  v_mfma_f32_16x16x32_bf16 v[132:135], v[72:75], v[152:155], v[132:135]
  v_mfma_f32_16x16x32_bf16 v[132:135], v[76:79], v[156:159], v[132:135]
  v_mfma_f32_16x16x32_bf16 v[136:139], v[96:99], v[144:147], 0
  v_mfma_f32_16x16x32_bf16 v[136:139], v[100:103], v[148:151], v[136:139]
  v_mfma_f32_16x16x32_bf16 v[136:139], v[104:107], v[152:155], v[136:139]
  v_mfma_f32_16x16x32_bf16 v[136:139], v[108:111], v[156:159], v[136:139]
  ds_read_b128 v[144:147], v24 offset:384
  ds_read_b128 v[148:151], v24 offset:448
  s_waitcnt lgkmcnt(2)
  v_mfma_f32_16x16x32_bf16 v[128:131], v[48:51], v[160:163], v[128:131]
  v_mfma_f32_16x16x32_bf16 v[128:131], v[52:55], v[164:167], v[128:131]
  v_mfma_f32_16x16x32_bf16 v[132:135], v[80:83], v[160:163], v[132:135]
  v_mfma_f32_16x16x32_bf16 v[132:135], v[84:87], v[164:167], v[132:135]
  v_mfma_f32_16x16x32_bf16 v[136:139], v[112:115], v[160:163], v[136:139]
  v_mfma_f32_16x16x32_bf16 v[136:139], v[116:119], v[164:167], v[136:139]
  s_waitcnt lgkmcnt(0)
  v_mfma_f32_16x16x32_bf16 v[128:131], v[56:59], v[144:147], v[128:131]
  v_mfma_f32_16x16x32_bf16 v[128:131], v[60:63], v[148:151], v[128:131]
  v_mfma_f32_16x16x32_bf16 v[132:135], v[88:91], v[144:147], v[132:135]
  v_mfma_f32_16x16x32_bf16 v[132:135], v[92:95], v[148:151], v[132:135]
  v_mfma_f32_16x16x32_bf16 v[136:139], v[120:123], v[144:147], v[136:139]
  v_mfma_f32_16x16x32_bf16 v[136:139], v[124:127], v[148:151], v[136:139]
  ds_read_b128 v[32:35], v8 offset:8192
  ds_read_b128 v[36:39], v9 offset:8192
  ds_read_b128 v[40:43], v10 offset:8192
  ds_read_b128 v[44:47], v11 offset:8192
  ds_read_b128 v[48:51], v8 offset:8448
  ds_read_b128 v[52:55], v9 offset:8448
  ds_read_b128 v[56:59], v10 offset:8448
  ds_read_b128 v[60:63], v11 offset:8448
  ds_read_b128 v[64:67], v24 offset:0
  ds_read_b128 v[68:71], v24 offset:64
  ds_read_b128 v[72:75], v24 offset:128
  ds_read_b128 v[76:79], v24 offset:192
  ds_read_b128 v[80:83], v24 offset:256
  ds_read_b128 v[84:87], v24 offset:320
  ds_read_b128 v[88:91], v24 offset:384
  ds_read_b128 v[92:95], v24 offset:448
  s_waitcnt lgkmcnt(0)
  s_xor_b32 m0, s59, 8192
  s_xor_b32 s60, s58, 524288
  buffer_load_dwordx4 v4, s[12:15], s60 offen offset:0 nt lds
  buffer_load_dwordx4 v5, s[12:15], s60 offen offset:1024 nt lds
  buffer_load_dwordx4 v6, s[12:15], s60 offen offset:2048 nt lds
  buffer_load_dwordx4 v7, s[12:15], s60 offen offset:3072 nt lds
  v_mfma_f32_16x16x32_bf16 v[140:143], v[32:35], v[64:67], 0
  v_mfma_f32_16x16x32_bf16 v[140:143], v[36:39], v[68:71], v[140:143]
  v_mfma_f32_16x16x32_bf16 v[140:143], v[40:43], v[72:75], v[140:143]
  v_mfma_f32_16x16x32_bf16 v[140:143], v[44:47], v[76:79], v[140:143]
  v_mfma_f32_16x16x32_bf16 v[140:143], v[48:51], v[80:83], v[140:143]
  v_mfma_f32_16x16x32_bf16 v[140:143], v[52:55], v[84:87], v[140:143]
  v_mfma_f32_16x16x32_bf16 v[140:143], v[56:59], v[88:91], v[140:143]
  v_mfma_f32_16x16x32_bf16 v[140:143], v[60:63], v[92:95], v[140:143]
  s_mov_b32 s84, 0x00030003
  s_mov_b32 s85, 0x00030003
  s_lshl_b64 s[86:87], s[84:85], 2
  s_lshl_b64 s[88:89], s[84:85], 4
  s_lshl_b64 s[90:91], s[84:85], 6
  s_lshl_b64 s[92:93], s[84:85], 8
  s_lshl_b64 s[94:95], s[84:85], 10
  s_lshl_b64 s[96:97], s[84:85], 12
  s_lshl_b64 s[98:99], s[84:85], 14
  s_mov_b32 s63, 0x3db8aa3b
  v_cvt_pk_bf16_f32 v129, v128, v129
  v_lshlrev_b32 v128, 16, v129
  v_and_b32 v129, 0xffff0000, v129
  v_cvt_pk_bf16_f32 v131, v130, v131
  v_lshlrev_b32 v130, 16, v131
  v_and_b32 v131, 0xffff0000, v131
  v_cvt_pk_bf16_f32 v133, v132, v133
  v_lshlrev_b32 v132, 16, v133
  v_and_b32 v133, 0xffff0000, v133
  v_cvt_pk_bf16_f32 v135, v134, v135
  v_lshlrev_b32 v134, 16, v135
  v_and_b32 v135, 0xffff0000, v135
  v_cvt_pk_bf16_f32 v137, v136, v137
  v_lshlrev_b32 v136, 16, v137
  v_and_b32 v137, 0xffff0000, v137
  v_cvt_pk_bf16_f32 v139, v138, v139
  v_lshlrev_b32 v138, 16, v139
  v_and_b32 v139, 0xffff0000, v139
  v_cvt_pk_bf16_f32 v141, v140, v141
  v_lshlrev_b32 v140, 16, v141
  v_and_b32 v141, 0xffff0000, v141
  v_cvt_pk_bf16_f32 v143, v142, v143
  v_lshlrev_b32 v142, 16, v143
  v_and_b32 v143, 0xffff0000, v143
  v_max3_f32 v22, v128, v129, v130
  v_max3_f32 v22, v22, v131, v132
  v_max3_f32 v22, v22, v133, v134
  v_max3_f32 v22, v22, v135, v136
  v_max3_f32 v22, v22, v137, v138
  v_max3_f32 v22, v22, v139, v140
  v_max3_f32 v22, v22, v141, v142
  v_max_f32 v22, v22, v143
  v_mov_b32 v1, v22
  s_nop 1
  v_permlane16_swap_b32 v22, v1
  v_max_f32 v22, v22, v1
  v_mov_b32 v1, v22
  s_nop 1
  v_permlane32_swap_b32 v22, v1
  v_max_f32 v22, v22, v1
  v_sub_f32 v128, v128, v22
  v_sub_f32 v129, v129, v22
  v_sub_f32 v130, v130, v22
  v_sub_f32 v131, v131, v22
  v_sub_f32 v132, v132, v22
  v_sub_f32 v133, v133, v22
  v_sub_f32 v134, v134, v22
  v_sub_f32 v135, v135, v22
  v_sub_f32 v136, v136, v22
  v_sub_f32 v137, v137, v22
  v_sub_f32 v138, v138, v22
  v_sub_f32 v139, v139, v22
  v_sub_f32 v140, v140, v22
  v_sub_f32 v141, v141, v22
  v_sub_f32 v142, v142, v22
  v_sub_f32 v143, v143, v22
  v_mul_f32 v128, s63, v128
  v_mul_f32 v129, s63, v129
  v_mul_f32 v130, s63, v130
  v_mul_f32 v131, s63, v131
  v_mul_f32 v132, s63, v132
  v_mul_f32 v133, s63, v133
  v_mul_f32 v134, s63, v134
  v_mul_f32 v135, s63, v135
  v_mul_f32 v136, s63, v136
  v_mul_f32 v137, s63, v137
  v_mul_f32 v138, s63, v138
  v_mul_f32 v139, s63, v139
  v_mul_f32 v140, s63, v140
  v_mul_f32 v141, s63, v141
  v_mul_f32 v142, s63, v142
  v_mul_f32 v143, s63, v143
  v_exp_f32 v128, v128
  v_exp_f32 v129, v129
  v_exp_f32 v130, v130
  v_exp_f32 v131, v131
  v_exp_f32 v132, v132
  v_exp_f32 v133, v133
  v_exp_f32 v134, v134
  v_exp_f32 v135, v135
  v_exp_f32 v136, v136
  v_exp_f32 v137, v137
  v_exp_f32 v138, v138
  v_exp_f32 v139, v139
  v_exp_f32 v140, v140
  v_exp_f32 v141, v141
  v_exp_f32 v142, v142
  v_exp_f32 v143, v143
  v_cvt_pk_bf16_f32 v144, v128, v129
  v_cvt_pk_bf16_f32 v145, v130, v131
  v_cvt_pk_bf16_f32 v146, v132, v133
  v_cvt_pk_bf16_f32 v147, v134, v135
  v_cvt_pk_bf16_f32 v148, v136, v137
  v_cvt_pk_bf16_f32 v149, v138, v139
  v_cvt_pk_bf16_f32 v150, v140, v141
  v_cvt_pk_bf16_f32 v151, v142, v143
  v_add_f32 v128, v128, v136
  v_add_f32 v129, v129, v137
  v_add_f32 v130, v130, v138
  v_add_f32 v131, v131, v139
  v_add_f32 v132, v132, v140
  v_add_f32 v133, v133, v141
  v_add_f32 v134, v134, v142
  v_add_f32 v135, v135, v143
  v_add_f32 v128, v128, v132
  v_add_f32 v129, v129, v133
  v_add_f32 v130, v130, v134
  v_add_f32 v131, v131, v135
  v_add_f32 v128, v128, v130
  v_add_f32 v129, v129, v131
  v_add_f32 v23, v128, v129
  v_mov_b32 v1, v23
  s_nop 1
  v_permlane16_swap_b32 v23, v1
  v_add_f32 v23, v23, v1
  v_mov_b32 v1, v23
  s_nop 1
  v_permlane32_swap_b32 v23, v1
  v_add_f32 v23, v23, v1
  s_mov_b64 exec, 3
  ds_write_b64 v25, v[22:23]
  s_mov_b64 exec, 1
  ds_add_u32 v26, v28 offset:4
  s_mov_b64 exec, -1
  s_waitcnt lgkmcnt(0)
  s_movk_i32 s61, 896
  v_mad_u32_u24 v23, v31, s61, v30
  v_bfe_u32 v1, v0, 3, 1
  v_lshlrev_b32 v1, 8, v1
  v_and_b32 v3, 16, v0
  v_add_u32 v1, v1, v3
  v_lshrrev_b32 v3, 5, v0
  v_add_u32 v1, v1, v3
  v_mad_u32_u24 v22, v1, s61, v30
  v_lshrrev_b32 v1, 2, v0
  v_lshlrev_b32 v1, 7, v1
  v_bfe_u32 v2, v0, 3, 2
  v_lshl_add_u32 v1, v2, 5, v1
  v_and_b32 v2, 3, v0
  v_lshl_add_u32 v1, v2, 3, v1
  v_add_u32 v8, s59, v1
  v_xor_b32 v9, 32, v8
  v_xor_b32 v10, 64, v8
  v_xor_b32 v11, 0x60, v8
  v_lshlrev_b32 v1, 4, v0
  s_lshl_b32 s60, s3, 11
  s_add_u32 s60, s60, 131072
  v_add_u32 v24, s60, v1
  v_lshrrev_b32 v2, 4, v0
  v_and_b32 v3, 15, v0
  v_lshlrev_b32 v31, 12, v2
  v_lshl_add_u32 v31, v3, 4, v31
  s_lshl_b32 s60, s3, 8
  s_add_u32 s61, s60, 131072
  v_add_u32 v25, s61, v31
  s_add_u32 s61, s60, 149504
  v_lshlrev_b32 v31, 2, v0
  v_add_u32 v29, s61, v31
  s_lshl3_add_u32 s60, s56, s3
  s_lshl_b32 s60, s60, 10
  s_add_u32 s60, s60, 262144
  v_add_u32 v28, s60, v1
  s_lshl4_add_u32 s61, s5, s60
  v_and_b32 v1, 3, v0
  v_lshlrev_b32 v1, 8, v1
  v_and_b32 v3, 4, v0
  v_lshl_add_u32 v1, v3, 1, v1
  v_and_b32 v3, 8, v0
  v_lshl_add_u32 v1, v3, 4, v1
  v_add_u32 v27, s61, v1
  s_lshl_b32 s60, s3, 6
  s_add_u32 s60, s60, 147968
  v_lshlrev_b32 v1, 3, v2
  v_add_u32 v21, s60, v1
  v_lshlrev_b32 v31, 4, v2
  v_add_u32 v31, 147584, v31
  s_mul_i32 s60, s6, 7
  s_add_u32 s60, s60, s5
  s_lshl3_add_u32 s60, s60, s4
  s_lshl_b32 s60, s60, 8
  s_add_u32 s60, s60, 1835008
  v_lshl_add_u32 v30, v0, 2, s60
  v_cndmask_b32 v64, 0, v144, s[84:85]
  v_cndmask_b32 v65, 0, v145, s[84:85]
  v_cndmask_b32 v66, 0, v144, s[86:87]
  v_cndmask_b32 v67, 0, v145, s[86:87]
  v_cndmask_b32 v68, 0, v144, s[88:89]
  v_cndmask_b32 v69, 0, v145, s[88:89]
  v_cndmask_b32 v70, 0, v144, s[90:91]
  v_cndmask_b32 v71, 0, v145, s[90:91]
  v_cndmask_b32 v72, 0, v144, s[92:93]
  v_cndmask_b32 v73, 0, v145, s[92:93]
  v_cndmask_b32 v74, 0, v144, s[94:95]
  v_cndmask_b32 v75, 0, v145, s[94:95]
  v_cndmask_b32 v76, 0, v144, s[96:97]
  v_cndmask_b32 v77, 0, v145, s[96:97]
  v_cndmask_b32 v78, 0, v144, s[98:99]
  v_cndmask_b32 v79, 0, v145, s[98:99]
  s_waitcnt vmcnt(4)
  ds_read_b64_tr_b16 v[32:33], v12 offset:0
  ds_read_b64_tr_b16 v[34:35], v13 offset:0
  ds_read_b64_tr_b16 v[36:37], v14 offset:0
  ds_read_b64_tr_b16 v[38:39], v15 offset:0
  ds_read_b64_tr_b16 v[40:41], v16 offset:0
  ds_read_b64_tr_b16 v[42:43], v17 offset:0
  ds_read_b64_tr_b16 v[44:45], v18 offset:0
  ds_read_b64_tr_b16 v[46:47], v19 offset:0
  ds_read_b64_tr_b16 v[48:49], v12 offset:256
  ds_read_b64_tr_b16 v[50:51], v13 offset:256
  ds_read_b64_tr_b16 v[52:53], v14 offset:256
  ds_read_b64_tr_b16 v[54:55], v15 offset:256
  ds_read_b64_tr_b16 v[56:57], v16 offset:256
  ds_read_b64_tr_b16 v[58:59], v17 offset:256
  ds_read_b64_tr_b16 v[60:61], v18 offset:256
  ds_read_b64_tr_b16 v[62:63], v19 offset:256
  s_waitcnt lgkmcnt(14)
  v_mfma_f32_16x16x32_bf16 v[152:155], v[64:67], v[32:35], 0
  s_waitcnt lgkmcnt(12)
  v_mfma_f32_16x16x32_bf16 v[152:155], v[68:71], v[36:39], v[152:155]
  s_waitcnt lgkmcnt(10)
  v_mfma_f32_16x16x32_bf16 v[152:155], v[72:75], v[40:43], v[152:155]
  s_waitcnt lgkmcnt(8)
  v_mfma_f32_16x16x32_bf16 v[152:155], v[76:79], v[44:47], v[152:155]
  s_waitcnt lgkmcnt(6)
  v_mfma_f32_16x16x32_bf16 v[156:159], v[64:67], v[48:51], 0
  s_waitcnt lgkmcnt(4)
  v_mfma_f32_16x16x32_bf16 v[156:159], v[68:71], v[52:55], v[156:159]
  s_waitcnt lgkmcnt(2)
  v_mfma_f32_16x16x32_bf16 v[156:159], v[72:75], v[56:59], v[156:159]
  s_waitcnt lgkmcnt(0)
  v_mfma_f32_16x16x32_bf16 v[156:159], v[76:79], v[60:63], v[156:159]
  v_cndmask_b32 v80, 0, v146, s[84:85]
  v_cndmask_b32 v81, 0, v147, s[84:85]
  v_cndmask_b32 v82, 0, v146, s[86:87]
  v_cndmask_b32 v83, 0, v147, s[86:87]
  v_cndmask_b32 v84, 0, v146, s[88:89]
  v_cndmask_b32 v85, 0, v147, s[88:89]
  v_cndmask_b32 v86, 0, v146, s[90:91]
  v_cndmask_b32 v87, 0, v147, s[90:91]
  v_cndmask_b32 v88, 0, v146, s[92:93]
  v_cndmask_b32 v89, 0, v147, s[92:93]
  v_cndmask_b32 v90, 0, v146, s[94:95]
  v_cndmask_b32 v91, 0, v147, s[94:95]
  v_cndmask_b32 v92, 0, v146, s[96:97]
  v_cndmask_b32 v93, 0, v147, s[96:97]
  v_cndmask_b32 v94, 0, v146, s[98:99]
  v_cndmask_b32 v95, 0, v147, s[98:99]
  s_waitcnt vmcnt(1)
  s_xor_b32 m0, s59, 12288
  s_xor_b32 s60, s58, 528384
  buffer_load_dwordx4 v4, s[12:15], s60 offen offset:0 nt lds
  buffer_load_dwordx4 v5, s[12:15], s60 offen offset:1024 nt lds
  buffer_load_dwordx4 v6, s[12:15], s60 offen offset:2048 nt lds
  buffer_load_dwordx4 v7, s[12:15], s60 offen offset:3072 nt lds
  s_waitcnt vmcnt(1)
  s_add_u32 m0, s59, 0
  s_add_u32 s60, s64, 0
  buffer_load_dwordx4 v22, s[52:55], s60 offen lds
  s_add_u32 m0, s59, 1024
  s_add_u32 s60, s64, 1792
  buffer_load_dwordx4 v22, s[52:55], s60 offen lds
  s_add_u32 m0, s59, 2048
  s_add_u32 s60, s64, 3584
  buffer_load_dwordx4 v22, s[52:55], s60 offen lds
  s_add_u32 m0, s59, 3072
  s_add_u32 s60, s64, 5376
  buffer_load_dwordx4 v22, s[52:55], s60 offen lds
  s_waitcnt vmcnt(4)
  ds_read_b64_tr_b16 v[32:33], v12 offset:8192
  ds_read_b64_tr_b16 v[34:35], v13 offset:8192
  ds_read_b64_tr_b16 v[36:37], v14 offset:8192
  ds_read_b64_tr_b16 v[38:39], v15 offset:8192
  ds_read_b64_tr_b16 v[40:41], v16 offset:8192
  ds_read_b64_tr_b16 v[42:43], v17 offset:8192
  ds_read_b64_tr_b16 v[44:45], v18 offset:8192
  ds_read_b64_tr_b16 v[46:47], v19 offset:8192
  ds_read_b64_tr_b16 v[48:49], v12 offset:8448
  ds_read_b64_tr_b16 v[50:51], v13 offset:8448
  ds_read_b64_tr_b16 v[52:53], v14 offset:8448
  ds_read_b64_tr_b16 v[54:55], v15 offset:8448
  ds_read_b64_tr_b16 v[56:57], v16 offset:8448
  ds_read_b64_tr_b16 v[58:59], v17 offset:8448
  ds_read_b64_tr_b16 v[60:61], v18 offset:8448
  ds_read_b64_tr_b16 v[62:63], v19 offset:8448
  s_waitcnt lgkmcnt(14)
  v_mfma_f32_16x16x32_bf16 v[152:155], v[80:83], v[32:35], v[152:155]
  s_waitcnt lgkmcnt(12)
  v_mfma_f32_16x16x32_bf16 v[152:155], v[84:87], v[36:39], v[152:155]
  s_waitcnt lgkmcnt(10)
  v_mfma_f32_16x16x32_bf16 v[152:155], v[88:91], v[40:43], v[152:155]
  s_waitcnt lgkmcnt(8)
  v_mfma_f32_16x16x32_bf16 v[152:155], v[92:95], v[44:47], v[152:155]
  s_waitcnt lgkmcnt(6)
  v_mfma_f32_16x16x32_bf16 v[156:159], v[80:83], v[48:51], v[156:159]
  s_waitcnt lgkmcnt(4)
  v_mfma_f32_16x16x32_bf16 v[156:159], v[84:87], v[52:55], v[156:159]
  s_waitcnt lgkmcnt(2)
  v_mfma_f32_16x16x32_bf16 v[156:159], v[88:91], v[56:59], v[156:159]
  s_waitcnt lgkmcnt(0)
  v_mfma_f32_16x16x32_bf16 v[156:159], v[92:95], v[60:63], v[156:159]
  s_waitcnt vmcnt(1)
  s_add_u32 m0, s59, 4096
  s_add_u32 s60, s65, 0
  buffer_load_dwordx4 v23, s[48:51], s60 offen lds
  s_add_u32 m0, s59, 5120
  s_add_u32 s60, s65, 7168
  buffer_load_dwordx4 v23, s[48:51], s60 offen lds
  s_add_u32 m0, s59, 6144
  s_add_u32 s60, s65, 14336
  buffer_load_dwordx4 v23, s[48:51], s60 offen lds
  s_add_u32 m0, s59, 7168
  s_add_u32 s60, s65, 21504
  buffer_load_dwordx4 v23, s[48:51], s60 offen lds
  s_waitcnt vmcnt(1)
  s_xor_b32 m0, s59, 8192
  s_xor_b32 s60, s58, 1048576
  buffer_load_dwordx4 v4, s[12:15], s60 offen offset:0 nt lds
  buffer_load_dwordx4 v5, s[12:15], s60 offen offset:1024 nt lds
  buffer_load_dwordx4 v6, s[12:15], s60 offen offset:2048 nt lds
  buffer_load_dwordx4 v7, s[12:15], s60 offen offset:3072 nt lds
  v_cndmask_b32 v64, 0, v148, s[84:85]
  v_cndmask_b32 v65, 0, v149, s[84:85]
  v_cndmask_b32 v66, 0, v148, s[86:87]
  v_cndmask_b32 v67, 0, v149, s[86:87]
  v_cndmask_b32 v68, 0, v148, s[88:89]
  v_cndmask_b32 v69, 0, v149, s[88:89]
  v_cndmask_b32 v70, 0, v148, s[90:91]
  v_cndmask_b32 v71, 0, v149, s[90:91]
  v_cndmask_b32 v72, 0, v148, s[92:93]
  v_cndmask_b32 v73, 0, v149, s[92:93]
  v_cndmask_b32 v74, 0, v148, s[94:95]
  v_cndmask_b32 v75, 0, v149, s[94:95]
  v_cndmask_b32 v76, 0, v148, s[96:97]
  v_cndmask_b32 v77, 0, v149, s[96:97]
  v_cndmask_b32 v78, 0, v148, s[98:99]
  v_cndmask_b32 v79, 0, v149, s[98:99]
  s_waitcnt vmcnt(4)
  ds_read_b64_tr_b16 v[96:97], v8 offset:0
  ds_read_b64_tr_b16 v[98:99], v8 offset:2048
  ds_read_b64_tr_b16 v[100:101], v9 offset:0
  ds_read_b64_tr_b16 v[102:103], v9 offset:2048
  ds_read_b64_tr_b16 v[104:105], v10 offset:0
  ds_read_b64_tr_b16 v[106:107], v10 offset:2048
  ds_read_b64_tr_b16 v[108:109], v11 offset:0
  ds_read_b64_tr_b16 v[110:111], v11 offset:2048
  ds_read_b64_tr_b16 v[128:129], v8 offset:4096
  ds_read_b64_tr_b16 v[130:131], v8 offset:6144
  ds_read_b64_tr_b16 v[132:133], v9 offset:4096
  ds_read_b64_tr_b16 v[134:135], v9 offset:6144
  ds_read_b64_tr_b16 v[136:137], v10 offset:4096
  ds_read_b64_tr_b16 v[138:139], v10 offset:6144
  ds_read_b64_tr_b16 v[140:141], v11 offset:4096
  ds_read_b64_tr_b16 v[142:143], v11 offset:6144
  s_waitcnt vmcnt(1)
  s_xor_b32 m0, s59, 12288
  s_xor_b32 s60, s58, 1052672
  buffer_load_dwordx4 v4, s[12:15], s60 offen offset:0 nt lds
  buffer_load_dwordx4 v5, s[12:15], s60 offen offset:1024 nt lds
  buffer_load_dwordx4 v6, s[12:15], s60 offen offset:2048 nt lds
  buffer_load_dwordx4 v7, s[12:15], s60 offen offset:3072 nt lds
  s_waitcnt lgkmcnt(0)
  s_waitcnt vmcnt(2)
  s_xor_b32 m0, s59, 0
  s_xor_b32 s60, s58, 1572864
  buffer_load_dwordx4 v4, s[12:15], s60 offen offset:0 nt lds
  buffer_load_dwordx4 v5, s[12:15], s60 offen offset:1024 nt lds
  buffer_load_dwordx4 v6, s[12:15], s60 offen offset:2048 nt lds
  buffer_load_dwordx4 v7, s[12:15], s60 offen offset:3072 nt lds
  s_waitcnt vmcnt(4)
  ds_read_b64_tr_b16 v[32:33], v12 offset:8192
  ds_read_b64_tr_b16 v[34:35], v13 offset:8192
  ds_read_b64_tr_b16 v[36:37], v14 offset:8192
  ds_read_b64_tr_b16 v[38:39], v15 offset:8192
  ds_read_b64_tr_b16 v[40:41], v16 offset:8192
  ds_read_b64_tr_b16 v[42:43], v17 offset:8192
  ds_read_b64_tr_b16 v[44:45], v18 offset:8192
  ds_read_b64_tr_b16 v[46:47], v19 offset:8192
  ds_read_b64_tr_b16 v[48:49], v12 offset:8448
  ds_read_b64_tr_b16 v[50:51], v13 offset:8448
  ds_read_b64_tr_b16 v[52:53], v14 offset:8448
  ds_read_b64_tr_b16 v[54:55], v15 offset:8448
  ds_read_b64_tr_b16 v[56:57], v16 offset:8448
  ds_read_b64_tr_b16 v[58:59], v17 offset:8448
  ds_read_b64_tr_b16 v[60:61], v18 offset:8448
  ds_read_b64_tr_b16 v[62:63], v19 offset:8448
  s_xor_b32 m0, s59, 4096
  s_xor_b32 s60, s58, 1576960
  buffer_load_dwordx4 v4, s[12:15], s60 offen offset:0 nt lds
  buffer_load_dwordx4 v5, s[12:15], s60 offen offset:1024 nt lds
  buffer_load_dwordx4 v6, s[12:15], s60 offen offset:2048 nt lds
  buffer_load_dwordx4 v7, s[12:15], s60 offen offset:3072 nt lds
  s_waitcnt lgkmcnt(14)
  v_mfma_f32_16x16x32_bf16 v[152:155], v[64:67], v[32:35], v[152:155]
  s_waitcnt lgkmcnt(12)
  v_mfma_f32_16x16x32_bf16 v[152:155], v[68:71], v[36:39], v[152:155]
  s_waitcnt lgkmcnt(10)
  v_mfma_f32_16x16x32_bf16 v[152:155], v[72:75], v[40:43], v[152:155]
  s_waitcnt lgkmcnt(8)
  v_mfma_f32_16x16x32_bf16 v[152:155], v[76:79], v[44:47], v[152:155]
  s_waitcnt lgkmcnt(6)
  v_mfma_f32_16x16x32_bf16 v[156:159], v[64:67], v[48:51], v[156:159]
  s_waitcnt lgkmcnt(4)
  v_mfma_f32_16x16x32_bf16 v[156:159], v[68:71], v[52:55], v[156:159]
  s_waitcnt lgkmcnt(2)
  v_mfma_f32_16x16x32_bf16 v[156:159], v[72:75], v[56:59], v[156:159]
  s_waitcnt lgkmcnt(0)
  v_mfma_f32_16x16x32_bf16 v[156:159], v[76:79], v[60:63], v[156:159]
  v_mov_b32 v2, v150
  v_mov_b32 v3, v151
  v_lshrrev_b32 v1, 5, v0
  v_mul_u32_u24 v1, 0x1080, v1
  v_permlane32_swap_b32 v150, v2
  v_permlane32_swap_b32 v151, v3
  s_mov_b32 s85, s93
  v_xor_b32 v12, v12, v1
  s_mov_b32 s87, s95
  v_xor_b32 v13, v13, v1
  s_mov_b32 s89, s97
  v_xor_b32 v14, v14, v1
  s_mov_b32 s91, s99
  v_xor_b32 v15, v15, v1
  v_cndmask_b32 v80, 0, v150, s[84:85]
  v_cndmask_b32 v81, 0, v151, s[84:85]
  v_cndmask_b32 v82, 0, v150, s[86:87]
  v_cndmask_b32 v83, 0, v151, s[86:87]
  v_cndmask_b32 v84, 0, v150, s[88:89]
  v_cndmask_b32 v85, 0, v151, s[88:89]
  v_cndmask_b32 v86, 0, v150, s[90:91]
  v_cndmask_b32 v87, 0, v151, s[90:91]
  v_cndmask_b32 v88, 0, v2, s[84:85]
  v_cndmask_b32 v89, 0, v3, s[84:85]
  v_cndmask_b32 v90, 0, v2, s[86:87]
  v_cndmask_b32 v91, 0, v3, s[86:87]
  v_cndmask_b32 v92, 0, v2, s[88:89]
  v_cndmask_b32 v93, 0, v3, s[88:89]
  v_cndmask_b32 v94, 0, v2, s[90:91]
  v_cndmask_b32 v95, 0, v3, s[90:91]
  s_mov_b32 s61, 3200000
L_wf:
  ds_read_b32 v1, v26 offset:16
  s_sub_u32 s61, s61, 1
  s_waitcnt lgkmcnt(0)
  s_cbranch_scc1 L_wf_done
  v_readfirstlane_b32 s67, v1
  s_cmp_lg_u32 s67, 0
  s_cbranch_scc1 L_wf_done
  s_sleep 1
  s_branch L_wf
L_wf_done:
  ds_read_b128 v[4:7], v26 offset:16
  ds_read2_b64 v[64:67], v21 offset0:0 offset1:4
  s_mov_b32 s84, 0x00010001
  s_mov_b32 s85, 0x00010001
  s_mov_b32 s86, 0x01000100
  s_mov_b32 s87, 0x01000100
  s_mov_b32 s88, 0x00ff00ff
  s_mov_b32 s89, 0x00ff00ff
  s_waitcnt vmcnt(8)
  ds_read_b128 v[160:163], v31
  s_waitcnt lgkmcnt(0)
  v_readfirstlane_b32 s63, v5
  v_cndmask_b32 v68, 0, v64, s[84:85]
  v_cndmask_b32 v72, 0, v64, s[86:87]
  v_cndmask_b32 v69, 0, v65, s[84:85]
  v_cndmask_b32 v73, 0, v65, s[86:87]
  v_cndmask_b32 v70, 0, v66, s[84:85]
  v_cndmask_b32 v74, 0, v66, s[86:87]
  v_cndmask_b32 v71, 0, v67, s[84:85]
  v_cndmask_b32 v75, 0, v67, s[86:87]
  s_nop 0
  v_mfma_f32_16x16x32_bf16 v[144:147], v[68:71], v[128:131], 0
  v_mfma_f32_16x16x32_bf16 v[148:151], v[68:71], v[132:135], 0
  v_mfma_f32_16x16x32_bf16 v[144:147], v[72:75], v[136:139], v[144:147]
  v_mfma_f32_16x16x32_bf16 v[148:151], v[72:75], v[140:143], v[148:151]
  s_mov_b32 s62, 400000
  s_waitcnt vmcnt(4)
  ds_read_b64_tr_b16 v[32:33], v12 offset:0
  ds_read_b64_tr_b16 v[34:35], v13 offset:0
  ds_read_b64_tr_b16 v[36:37], v14 offset:0
  ds_read_b64_tr_b16 v[38:39], v15 offset:0
  ds_read_b64_tr_b16 v[40:41], v12 offset:256
  ds_read_b64_tr_b16 v[42:43], v13 offset:256
  ds_read_b64_tr_b16 v[44:45], v14 offset:256
  ds_read_b64_tr_b16 v[46:47], v15 offset:256
  s_waitcnt lgkmcnt(6)
  v_mfma_f32_16x16x32_bf16 v[152:155], v[80:83], v[32:35], v[152:155]
  s_waitcnt lgkmcnt(4)
  v_mfma_f32_16x16x32_bf16 v[152:155], v[84:87], v[36:39], v[152:155]
  s_waitcnt lgkmcnt(2)
  v_mfma_f32_16x16x32_bf16 v[156:159], v[80:83], v[40:43], v[156:159]
  s_waitcnt lgkmcnt(0)
  v_mfma_f32_16x16x32_bf16 v[156:159], v[84:87], v[44:47], v[156:159]
  s_waitcnt vmcnt(0)
  ds_read_b64_tr_b16 v[48:49], v12 offset:4096
  ds_read_b64_tr_b16 v[50:51], v13 offset:4096
  ds_read_b64_tr_b16 v[52:53], v14 offset:4096
  ds_read_b64_tr_b16 v[54:55], v15 offset:4096
  ds_read_b64_tr_b16 v[56:57], v12 offset:4352
  ds_read_b64_tr_b16 v[58:59], v13 offset:4352
  ds_read_b64_tr_b16 v[60:61], v14 offset:4352
  ds_read_b64_tr_b16 v[62:63], v15 offset:4352
  s_waitcnt lgkmcnt(6)
  v_mfma_f32_16x16x32_bf16 v[152:155], v[88:91], v[48:51], v[152:155]
  s_waitcnt lgkmcnt(4)
  v_mfma_f32_16x16x32_bf16 v[152:155], v[92:95], v[52:55], v[152:155]
  s_waitcnt lgkmcnt(2)
  v_mfma_f32_16x16x32_bf16 v[156:159], v[88:91], v[56:59], v[156:159]
  s_waitcnt lgkmcnt(0)
  v_mfma_f32_16x16x32_bf16 v[156:159], v[92:95], v[60:63], v[156:159]
  s_nop 3
  ds_write_b128 v24, v[152:155]
  s_nop 2
  ds_write_b128 v24, v[156:159] offset:1024
  s_add_u32 m0, s59, 12288
  s_add_u32 s60, s64, 7168
  buffer_load_dwordx4 v22, s[52:55], s60 offen lds
  s_add_u32 m0, s59, 13312
  s_add_u32 s60, s64, 8960
  buffer_load_dwordx4 v22, s[52:55], s60 offen lds
  s_add_u32 m0, s59, 14336
  s_add_u32 s60, s64, 10752
  buffer_load_dwordx4 v22, s[52:55], s60 offen lds
  s_add_u32 m0, s59, 15360
  s_add_u32 s60, s64, 12544
  buffer_load_dwordx4 v22, s[52:55], s60 offen lds
  s_waitcnt lgkmcnt(0)
  s_barrier
  ds_read_b128 v[32:35], v25
  ds_read_b128 v[36:39], v25 offset:2048
  s_cmp_eq_u32 s63, 0
  s_waitcnt lgkmcnt(1)
  v_pk_mul_f32 v[32:33], v[32:33], v[160:161]
  v_pk_mul_f32 v[34:35], v[34:35], v[160:161]
  s_waitcnt lgkmcnt(0)
  v_pk_fma_f32 v[32:33], v[36:37], v[162:163], v[32:33]
  v_pk_fma_f32 v[34:35], v[38:39], v[162:163], v[34:35]
  s_nop 1
  v_permlane32_swap_b32 v32, v34
  v_permlane32_swap_b32 v33, v35
  v_pk_add_f32 v[36:37], v[32:33], v[34:35]
  v_pk_add_f32 v[32:33], v[32:33], v[34:35]
  s_nop 1
  v_permlane16_swap_b32 v32, v36
  v_permlane16_swap_b32 v33, v37
  v_pk_add_f32 v[32:33], v[32:33], v[36:37]
  v_cvt_pk_bf16_f32 v32, v32, v33
  v_min_u32 v6, -2, v32
  v_min_u32 v7, -2, v32
  s_nop 1
  v_permlane32_swap_b32 v6, v7
  s_mov_b64 exec, 0xffff
  s_cbranch_scc1 L_slowpub
  buffer_store_dwordx2 v[6:7], v27, s[40:43], 0 offen
L_pubdone:
  s_mov_b64 exec, -1
  s_cmp_eq_u32 s5, 7
  s_cbranch_scc1 L_sdone
  buffer_load_dwordx4 v[64:67], v28, s[40:43], 0 offen sc1
  s_waitcnt vmcnt(1)
  ds_read_b64_tr_b16 v[112:113], v8 offset:12288
  ds_read_b64_tr_b16 v[114:115], v8 offset:14336
  ds_read_b64_tr_b16 v[116:117], v9 offset:12288
  ds_read_b64_tr_b16 v[118:119], v9 offset:14336
  ds_read_b64_tr_b16 v[120:121], v10 offset:12288
  ds_read_b64_tr_b16 v[122:123], v10 offset:14336
  ds_read_b64_tr_b16 v[124:125], v11 offset:12288
  ds_read_b64_tr_b16 v[126:127], v11 offset:14336
  s_branch L_poll1_chk
L_poll1:
  buffer_load_dwordx4 v[64:67], v28, s[40:43], 0 offen sc1
L_poll1_chk:
  s_sub_u32 s62, s62, 1
  s_waitcnt vmcnt(0)
  s_cbranch_scc1 L_poll1_done
  v_max3_u32 v1, v64, v65, v66
  v_max_u32 v1, v1, v67
  v_cmp_eq_u32 vcc, -1, v1
  s_mov_b64 exec, vcc
  s_cbranch_vccnz L_poll1
L_poll1_done:
  s_mov_b64 exec, -1
  v_cndmask_b32 v80, 0, v64, s[88:89]
  v_cndmask_b32 v81, 0, v65, s[88:89]
  v_cndmask_b32 v82, 0, v66, s[88:89]
  v_cndmask_b32 v83, 0, v67, s[88:89]
  v_cndmask_b32 v92, v64, 0, s[88:89]
  v_cndmask_b32 v93, v65, 0, s[88:89]
  v_cndmask_b32 v94, v66, 0, s[88:89]
  v_cndmask_b32 v95, v67, 0, s[88:89]
  s_waitcnt lgkmcnt(0)
  v_mfma_f32_16x16x32_bf16 v[144:147], v[80:83], v[96:99], v[144:147]
  v_mfma_f32_16x16x32_bf16 v[148:151], v[80:83], v[100:103], v[148:151]
  v_mov_b32_dpp v88, v64 row_shr:8 row_mask:0xf bank_mask:0xf bound_ctrl:0
  v_mov_b32_dpp v89, v65 row_shr:8 row_mask:0xf bank_mask:0xf bound_ctrl:0
  v_mov_b32_dpp v90, v66 row_shr:8 row_mask:0xf bank_mask:0xf bound_ctrl:0
  v_mov_b32_dpp v91, v67 row_shr:8 row_mask:0xf bank_mask:0xf bound_ctrl:0
  v_mfma_f32_16x16x32_bf16 v[144:147], v[92:95], v[120:123], v[144:147]
  v_mfma_f32_16x16x32_bf16 v[148:151], v[92:95], v[124:127], v[148:151]
  v_mov_b32_dpp v84, v64 row_shl:8 row_mask:0xf bank_mask:0xf bound_ctrl:0
  v_mov_b32_dpp v85, v65 row_shl:8 row_mask:0xf bank_mask:0xf bound_ctrl:0
  v_mov_b32_dpp v86, v66 row_shl:8 row_mask:0xf bank_mask:0xf bound_ctrl:0
  v_mov_b32_dpp v87, v67 row_shl:8 row_mask:0xf bank_mask:0xf bound_ctrl:0
  v_mfma_f32_16x16x32_bf16 v[144:147], v[88:91], v[104:107], v[144:147]
  v_mfma_f32_16x16x32_bf16 v[148:151], v[88:91], v[108:111], v[148:151]
  v_mfma_f32_16x16x32_bf16 v[144:147], v[84:87], v[112:115], v[144:147]
  v_mfma_f32_16x16x32_bf16 v[148:151], v[84:87], v[116:119], v[148:151]
  s_nop 6
  v_pk_add_f32 v[144:145], v[144:145], v[146:147]
  v_pk_add_f32 v[148:149], v[148:149], v[150:151]
  v_add_f32 v144, v144, v145
  v_add_f32 v148, v148, v149
  s_nop 1
  v_permlane16_swap_b32 v144, v148
  v_add_f32 v144, v144, v148
  ds_write_b32 v29, v144
  s_waitcnt lgkmcnt(0)
  s_cmp_lg_u32 s3, 0
  s_barrier
  s_cbranch_scc1 L_sdone
  ds_read_b32 v1, v26 offset:44
  ds_read2st64_b32 v[48:49], v29 offset0:0 offset1:1
  ds_read2st64_b32 v[50:51], v29 offset0:2 offset1:3
  ds_read2st64_b32 v[52:53], v29 offset0:4 offset1:5
  ds_read2st64_b32 v[54:55], v29 offset0:6 offset1:7
  s_waitcnt lgkmcnt(2)
  v_cmp_ne_u32 vcc, 0, v1
  v_add_f32 v48, v48, v49
  v_add_f32 v50, v50, v51
  s_cbranch_vccnz L_sdone
  s_waitcnt lgkmcnt(0)
  v_add_f32 v52, v52, v53
  v_add_f32 v54, v54, v55
  v_add_f32 v48, v48, v50
  v_add_f32 v52, v52, v54
  v_add_f32 v4, v48, v52
  v_min_u32 v4, -2, v4
  buffer_store_dword v4, v30, s[40:43], 0 offen sc1
L_sdone:
  s_endpgm
L_slowpub:
  buffer_store_dwordx2 v[6:7], v27, s[40:43], 0 offen sc1
  s_branch L_pubdone
.section .rodata,"a"
.p2align 6
.amdhsa_kernel parallel_sum__sliding_block_cached__glu_gated_reglu__decode_kernel
.amdhsa_next_free_vgpr 168
.amdhsa_next_free_sgpr 102
.amdhsa_accum_offset 168
.amdhsa_group_segment_fixed_size 0
.amdhsa_kernarg_size 96
.amdhsa_user_sgpr_count 2
.amdhsa_user_sgpr_kernarg_segment_ptr 1
.amdhsa_system_sgpr_workgroup_id_x 1
.end_amdhsa_kernel
```
